```python
import torch

def _softmax(x, axis=-1):
    return torch.softmax(x, dim=axis)
def _gelu(x):
    return torch.nn.functional.gelu(x, approximate="tanh")
def _silu(x):
    return torch.nn.functional.silu(x)
def _sigmoid(x):
    return torch.sigmoid(x)
def _layernorm(x, axis=-1, eps=1e-5):
    m = x.mean(dim=axis, keepdim=True)
    v = x.var(dim=axis, keepdim=True, unbiased=False)
    return (x - m) / torch.sqrt(v + eps)
def _scatter_add(tgt, idx, src, axis=0):
    return tgt.clone().index_add_(axis, idx, src)
def _segment_sum(src, seg, n):
    out = torch.zeros((n,) + src.shape[1:], dtype=src.dtype)
    return out.index_add_(0, seg, src)
def _pad(x, pw):
    flat = tuple(v for pair in reversed(pw) for v in pair)
    return torch.nn.functional.pad(x, flat)

kernel_name = 'standalone__weight_only_int_omniquant__prompt'

def setup_inputs():

    _w = (lambda a: (lambda t: t.to(torch.bfloat16) if t.is_floating_point() else t)(torch.as_tensor(a)))
    B, S, D, F = 1, 2048, 576, 4608
    bits = 8
    G = -1 if -1 > 0 else D
    D = (D // G) * G
    ng = D // G
    qmax = (1 << bits) - 1
    qw = torch.randint(0, qmax + 1, (D, F)).to(torch.int32)
    scales = (torch.abs((lambda *s: torch.randn(*s, dtype=torch.bfloat16) * 0.05)(ng, F)) * 0.05 + 0.01).to(float)
    zeros = torch.randint(0, qmax + 1, (ng, F)).to(float)
    act_scale = (torch.abs((lambda *s: torch.randn(*s, dtype=torch.bfloat16) * 0.05)(D)) * 0.5 + 0.5).to(float)
    return {
        "x": _w((lambda *s: torch.randn(*s, dtype=torch.bfloat16) * 0.05)(B, S, D)),
        "qw": _w(qw),
        "scales": _w(scales),
        "zeros": _w(zeros),
        "act_scale": _w(act_scale),
    }

def reference(x, qw, scales, zeros, act_scale):
    B, S, D = x.shape
    ng, F = scales.shape
    G = D // ng
    s = (lambda x, n, axis: torch.repeat_interleave(x, n, dim=axis))(scales, G, axis=0)
    z = (lambda x, n, axis: torch.repeat_interleave(x, n, dim=axis))(zeros, G, axis=0)
    w = ((lambda x, dt: x.to(dt))(qw, x.dtype) - z) * s
    xs = x * (lambda x, dt: x.to(dt))(act_scale, x.dtype)
    return torch.einsum("bsd,df->bsf", xs, w)
```

```asm
; @launch grid=(256,1,1) block=(512,1,1) lds=159744
.amdgcn_target "amdgcn-amd-amdhsa--gfx950"
.text
.globl standalone__weight_only_int_omniquant__prompt_kernel
.p2align 8
.type standalone__weight_only_int_omniquant__prompt_kernel,@function
standalone__weight_only_int_omniquant__prompt_kernel:
    s_cmp_ge_u32 s2, 256
    s_cbranch_scc1 L_done
    s_load_dwordx2 s[20:21], s[0:1], 8
    s_load_dwordx2 s[16:17], s[0:1], 0
    s_load_dwordx2 s[24:25], s[0:1], 16
    s_load_dwordx2 s[28:29], s[0:1], 24
    s_load_dwordx2 s[32:33], s[0:1], 32
    s_load_dwordx2 s[36:37], s[0:1], 40
    v_lshrrev_b32 v2, 6, v0
    v_and_b32 v1, 63, v0
    s_and_b32 s40, s2, 7
    s_lshr_b32 s41, s2, 3
    v_readfirstlane_b32 s46, v2
    s_cmp_lg_u32 s46, 0
    s_cbranch_scc1 L_nopf
    s_getpc_b64 s[78:79]
L_pc:
    s_lshl_b32 s50, s41, 10
    s_min_u32 s50, s50, L_done-standalone__weight_only_int_omniquant__prompt_kernel-1024
    s_sub_u32 s50, s50, L_pc-standalone__weight_only_int_omniquant__prompt_kernel
    s_ashr_i32 s51, s50, 31
    s_add_u32 s78, s78, s50
    s_addc_u32 s79, s79, s51
    v_lshlrev_b32 v12, 4, v1
    v_mov_b32 v13, s79
    v_add_co_u32 v12, vcc, s78, v12
    s_nop 1
    v_addc_co_u32 v13, vcc, 0, v13, vcc
    global_load_dwordx4 v[16:19], v[12:13], off
L_nopf:
    s_mul_i32 s43, s41, 37
    s_lshr_b32 s43, s43, 8
    s_mul_i32 s50, s43, 7
    s_sub_u32 s42, s41, s50
    s_and_b32 s51, s40, 1
    s_lshr_b32 s52, s40, 1
    s_mul_i32 s52, s52, 9
    s_mul_i32 s53, s51, 5
    s_add_u32 s44, s52, s43
    s_add_u32 s53, s44, s53
    s_lshl_b32 s54, s51, 2
    s_add_u32 s54, s42, s54
    s_cmp_lt_u32 s41, 28
    s_cselect_b32 s44, s53, s44
    s_cselect_b32 s42, s42, s54
    s_cmp_gt_u32 s42, 6
    s_cbranch_scc1 L_done
    s_mov_b32 s48, 470944256
    s_mov_b32 s49, 3550756
    s_lshl_b32 s50, s42, 3
    s_lshr_b64 s[48:49], s[48:49], s50
    s_and_b32 s45, s48, 0xff
    s_lshl_b32 s45, s45, 5
    s_lshl_b32 s50, s42, 2
    s_lshr_b32 s47, 176851594, s50
    s_and_b32 s47, s47, 15
    s_add_u32 s50, s42, s43
    s_and_b32 s50, s50, 3
    s_mov_b32 s48, 1984246273
    s_cmp_eq_u32 s50, 2
    s_cselect_b32 s48, 1969500448, s48
    s_cmp_eq_u32 s50, 3
    s_cselect_b32 s48, 1733567248, s48
    s_cmp_eq_u32 s50, 0
    s_cselect_b32 s48, 1985167888, s48
    s_mul_i32 s51, s40, 286331153
    s_cselect_b32 s52, 15, 0
    s_add_u32 s48, s48, s51
    s_and_b32 s48, s48, 0x77777777
    s_add_u32 s48, s48, 0x11111111
    s_and_b32 s59, s48, s52
    s_andn2_b32 s48, s48, s52
    s_mov_b32 s18, 2359296
    s_mov_b32 s19, 0x20000
    s_cmp_lt_u32 s46, 4
    s_cbranch_scc1 L_consumer
    s_mov_b32 s22, 10616832
    s_mov_b32 s23, 0x20000
    v_and_b32 v7, 31, v0
    v_bfe_u32 v2, v0, 5, 3
    v_mul_u32_u24 v104, 147456, v2
    v_lshl_add_u32 v104, v7, 4, v104
    s_lshl_b32 s50, s44, 9
    v_add_u32 v104, s50, v104
    v_add_u32 v105, 18432, v104
    v_add_u32 v106, 36864, v104
    v_add_u32 v107, 55296, v104
    v_add_u32 v108, 73728, v104
    v_add_u32 v109, 92160, v104
    v_add_u32 v110, 110592, v104
    v_add_u32 v111, 129024, v104
    s_mul_i32 s55, s59, 1179648
    s_sub_u32 s46, s46, 4
    s_waitcnt lgkmcnt(0)
    buffer_load_dwordx4 v[16:19], v104, s[20:23], s55 offen
    buffer_load_dwordx4 v[20:23], v105, s[20:23], s55 offen
    buffer_load_dwordx4 v[24:27], v106, s[20:23], s55 offen
    buffer_load_dwordx4 v[28:31], v107, s[20:23], s55 offen
    s_mov_b32 s26, 9216
    s_mov_b32 s27, 0x20000
    s_mov_b32 s30, 9216
    s_mov_b32 s31, 0x20000
    s_mov_b32 s34, 1152
    s_mov_b32 s35, 0x20000
    s_lshl_b32 s50, s44, 8
    v_lshl_add_u32 v9, v7, 3, s50
    v_lshrrev_b32 v3, 2, v1
    v_lshlrev_b32 v3, 7, v3
    v_and_b32 v4, 3, v1
    v_lshl_add_u32 v3, v4, 3, v3
    s_lshl_b32 s50, s46, 5
    v_add_u32 v3, s50, v3
    buffer_load_dwordx2 v[12:13], v3, s[32:35], 0 offen
    buffer_load_dwordx2 v[10:11], v9, s[24:27], 0 offen
    buffer_load_dwordx2 v[14:15], v9, s[28:31], 0 offen
    s_mul_i32 s54, s46, s47
    s_lshl_b32 s51, s54, 2
    s_lshl_b32 s50, s54, 3
    s_add_u32 s50, s50, s45
    v_lshrrev_b32 v4, 3, v1
    v_add_u32 v4, s50, v4
    v_mul_u32_u24 v4, 1152, v4
    v_lshrrev_b32 v8, 4, v1
    v_add_u32 v8, s51, v8
    v_xor_b32 v8, v8, v1
    v_and_b32 v8, 7, v8
    v_lshl_add_u32 v112, v8, 4, v4
    v_xor_b32 v113, 64, v112
    s_lshl_b32 s53, s54, 10
    s_add_u32 m0, s53, 36864
    s_lshl_b32 s52, s59, 7
    buffer_load_dwordx4 v112, s[16:19], s52 offen lds
    s_add_u32 m0, m0, 1024
    s_add_u32 s52, s52, 9216
    buffer_load_dwordx4 v113, s[16:19], s52 offen lds
    s_add_u32 m0, m0, 1024
    s_add_u32 s52, s52, 9216
    buffer_load_dwordx4 v112, s[16:19], s52 offen lds
    s_add_u32 m0, m0, 1024
    s_add_u32 s52, s52, 9216
    buffer_load_dwordx4 v113, s[16:19], s52 offen lds
    buffer_load_dwordx4 v[32:35], v108, s[20:23], s55 offen
    buffer_load_dwordx4 v[36:39], v109, s[20:23], s55 offen
    buffer_load_dwordx4 v[40:43], v110, s[20:23], s55 offen
    buffer_load_dwordx4 v[44:47], v111, s[20:23], s55 offen
    s_add_u32 m0, m0, 1024
    s_add_u32 s52, s52, 9216
    buffer_load_dwordx4 v112, s[16:19], s52 offen lds
    s_add_u32 m0, m0, 1024
    s_add_u32 s52, s52, 9216
    buffer_load_dwordx4 v113, s[16:19], s52 offen lds
    s_add_u32 m0, m0, 1024
    s_add_u32 s52, s52, 9216
    buffer_load_dwordx4 v112, s[16:19], s52 offen lds
    s_add_u32 m0, m0, 1024
    s_add_u32 s52, s52, 9216
    buffer_load_dwordx4 v113, s[16:19], s52 offen lds
    s_cmp_le_u32 s47, 8
    s_cbranch_scc1 L_x0done
    s_add_u32 m0, m0, 1024
    s_add_u32 s52, s52, 9216
    buffer_load_dwordx4 v112, s[16:19], s52 offen lds
    s_cmp_le_u32 s47, 9
    s_cbranch_scc1 L_x0done
    s_add_u32 m0, m0, 1024
    s_add_u32 s52, s52, 9216
    buffer_load_dwordx4 v113, s[16:19], s52 offen lds
L_x0done:
    s_mov_b32 s72, 8
    s_cmp_eq_u32 s47, 10
    s_cselect_b32 s72, 5, s72
    s_sub_u32 s73, s47, s72
    s_mul_i32 s54, s46, s73
    s_lshl_b32 s50, s72, 2
    s_add_u32 s54, s54, s50
    s_lshl_b32 s51, s54, 2
    s_lshl_b32 s50, s54, 3
    s_add_u32 s50, s50, s45
    v_lshrrev_b32 v4, 3, v1
    v_add_u32 v4, s50, v4
    v_mul_u32_u24 v4, 1152, v4
    v_lshrrev_b32 v8, 4, v1
    v_add_u32 v8, s51, v8
    v_xor_b32 v8, v8, v1
    v_and_b32 v8, 7, v8
    v_lshl_add_u32 v112, v8, 4, v4
    v_xor_b32 v113, 64, v112
    s_lshl_b32 s53, s54, 10
    s_add_u32 s74, s53, 36864
    s_add_u32 s75, s74, 122880
    s_add_u32 s53, s74, 0
    v_lshrrev_b32 v8, 1, v7
    v_and_b32 v9, 1, v7
    v_lshlrev_b32 v5, 13, v9
    v_lshl_add_u32 v5, v8, 7, v5
    v_lshlrev_b32 v9, 2, v9
    v_xor_b32 v9, v9, v2
    v_lshrrev_b32 v3, 1, v8
    v_xor_b32 v9, v9, v3
    v_and_b32 v8, 1, v8
    v_lshlrev_b32 v8, 1, v8
    v_xor_b32 v9, v9, v8
    v_lshl_add_u32 v5, v9, 4, v5
    s_lshl_b32 s50, s46, 10
    s_add_u32 s50, s50, 32768
    v_lshl_add_u32 v4, v1, 4, s50
    v_and_b32 v8, 1, v2
    v_lshl_add_u32 v6, v8, 5, s50
    s_mov_b32 s56, 0
    s_waitcnt vmcnt(12)
    v_lshlrev_b32 v80, 16, v12
    v_and_b32 v81, 0xffff0000, v12
    v_lshlrev_b32 v82, 16, v13
    v_and_b32 v83, 0xffff0000, v13
    ds_write_b128 v4, v[80:83]
    v_lshlrev_b32 v8, 16, v10
    v_and_b32 v9, 0xffff0000, v10
    v_lshlrev_b32 v10, 16, v11
    v_and_b32 v11, 0xffff0000, v11
    v_lshlrev_b32 v12, 16, v14
    v_and_b32 v13, 0xffff0000, v14
    v_lshlrev_b32 v14, 16, v15
    v_and_b32 v15, 0xffff0000, v15
    v_mul_f32_e64 v12, -v12, v8
    v_mul_f32_e64 v13, -v13, v9
    v_mul_f32_e64 v14, -v14, v10
    v_mul_f32_e64 v15, -v15, v11
    v_mul_f32 v8, 0x4b800000, v8
    v_mul_f32 v9, 0x4b800000, v9
    v_mul_f32 v10, 0x4b800000, v10
    v_mul_f32 v11, 0x4b800000, v11
    s_waitcnt lgkmcnt(0)
    s_lshl_b32 s50, s59, 6
    v_add_u32 v7, s50, v6
    ds_read_b128 v[96:99], v7
    ds_read_b128 v[100:103], v7 offset:16
    s_and_b32 s59, s48, 15
    s_lshr_b32 s48, s48, 4
    s_mul_i32 s55, s59, 1179648
    s_add_u32 s53, s53, 40960
    s_cmp_ge_u32 s53, s75
    s_cselect_b32 s53, s74, s53
    s_waitcnt vmcnt(4)
    v_fma_mix_f32 v48, v16, v8, v12 op_sel_hi:[1,0,0]
    v_fma_mix_f32 v49, v17, v9, v13 op_sel_hi:[1,0,0]
    v_fma_mix_f32 v50, v18, v10, v14 op_sel_hi:[1,0,0]
    v_fma_mix_f32 v51, v19, v11, v15 op_sel_hi:[1,0,0]
    v_fma_mix_f32 v52, v20, v8, v12 op_sel_hi:[1,0,0]
    v_fma_mix_f32 v53, v21, v9, v13 op_sel_hi:[1,0,0]
    v_fma_mix_f32 v54, v22, v10, v14 op_sel_hi:[1,0,0]
    v_fma_mix_f32 v55, v23, v11, v15 op_sel_hi:[1,0,0]
    v_fma_mix_f32 v56, v24, v8, v12 op_sel_hi:[1,0,0]
    v_fma_mix_f32 v57, v25, v9, v13 op_sel_hi:[1,0,0]
    v_fma_mix_f32 v58, v26, v10, v14 op_sel_hi:[1,0,0]
    v_fma_mix_f32 v59, v27, v11, v15 op_sel_hi:[1,0,0]
    v_fma_mix_f32 v60, v28, v8, v12 op_sel_hi:[1,0,0]
    v_fma_mix_f32 v61, v29, v9, v13 op_sel_hi:[1,0,0]
    v_fma_mix_f32 v62, v30, v10, v14 op_sel_hi:[1,0,0]
    v_fma_mix_f32 v63, v31, v11, v15 op_sel_hi:[1,0,0]
    v_fma_mix_f32 v64, v32, v8, v12 op_sel_hi:[1,0,0]
    v_fma_mix_f32 v65, v33, v9, v13 op_sel_hi:[1,0,0]
    v_fma_mix_f32 v66, v34, v10, v14 op_sel_hi:[1,0,0]
    v_fma_mix_f32 v67, v35, v11, v15 op_sel_hi:[1,0,0]
    v_fma_mix_f32 v68, v36, v8, v12 op_sel_hi:[1,0,0]
    v_fma_mix_f32 v69, v37, v9, v13 op_sel_hi:[1,0,0]
    v_fma_mix_f32 v70, v38, v10, v14 op_sel_hi:[1,0,0]
    v_fma_mix_f32 v71, v39, v11, v15 op_sel_hi:[1,0,0]
    v_fma_mix_f32 v72, v40, v8, v12 op_sel_hi:[1,0,0]
    v_fma_mix_f32 v73, v41, v9, v13 op_sel_hi:[1,0,0]
    v_fma_mix_f32 v74, v42, v10, v14 op_sel_hi:[1,0,0]
    v_fma_mix_f32 v75, v43, v11, v15 op_sel_hi:[1,0,0]
    v_fma_mix_f32 v76, v44, v8, v12 op_sel_hi:[1,0,0]
    v_fma_mix_f32 v77, v45, v9, v13 op_sel_hi:[1,0,0]
    v_fma_mix_f32 v78, v46, v10, v14 op_sel_hi:[1,0,0]
    v_fma_mix_f32 v79, v47, v11, v15 op_sel_hi:[1,0,0]
    s_waitcnt lgkmcnt(0)
    v_mul_f32 v48, v48, v96
    v_mul_f32 v49, v49, v96
    v_mul_f32 v50, v50, v96
    v_mul_f32 v51, v51, v96
    v_mul_f32 v52, v52, v97
    v_mul_f32 v53, v53, v97
    v_mul_f32 v54, v54, v97
    v_mul_f32 v55, v55, v97
    v_cvt_pk_bf16_f32 v80, v48, v52
    v_cvt_pk_bf16_f32 v84, v49, v53
    v_cvt_pk_bf16_f32 v88, v50, v54
    v_cvt_pk_bf16_f32 v92, v51, v55
    buffer_load_dwordx4 v[16:19], v104, s[20:23], s55 offen
    buffer_load_dwordx4 v[20:23], v105, s[20:23], s55 offen
    v_mul_f32 v56, v56, v98
    v_mul_f32 v57, v57, v98
    v_mul_f32 v58, v58, v98
    v_mul_f32 v59, v59, v98
    v_mul_f32 v60, v60, v99
    v_mul_f32 v61, v61, v99
    v_mul_f32 v62, v62, v99
    v_mul_f32 v63, v63, v99
    v_cvt_pk_bf16_f32 v81, v56, v60
    v_cvt_pk_bf16_f32 v85, v57, v61
    v_cvt_pk_bf16_f32 v89, v58, v62
    v_cvt_pk_bf16_f32 v93, v59, v63
    buffer_load_dwordx4 v[24:27], v106, s[20:23], s55 offen
    buffer_load_dwordx4 v[28:31], v107, s[20:23], s55 offen
    v_mul_f32 v64, v64, v100
    v_mul_f32 v65, v65, v100
    v_mul_f32 v66, v66, v100
    v_mul_f32 v67, v67, v100
    v_mul_f32 v68, v68, v101
    v_mul_f32 v69, v69, v101
    v_mul_f32 v70, v70, v101
    v_mul_f32 v71, v71, v101
    v_cvt_pk_bf16_f32 v82, v64, v68
    v_cvt_pk_bf16_f32 v86, v65, v69
    v_cvt_pk_bf16_f32 v90, v66, v70
    v_cvt_pk_bf16_f32 v94, v67, v71
    buffer_load_dwordx4 v[32:35], v108, s[20:23], s55 offen
    buffer_load_dwordx4 v[36:39], v109, s[20:23], s55 offen
    v_mul_f32 v72, v72, v102
    v_mul_f32 v73, v73, v102
    v_mul_f32 v74, v74, v102
    v_mul_f32 v75, v75, v102
    v_mul_f32 v76, v76, v103
    v_mul_f32 v77, v77, v103
    v_mul_f32 v78, v78, v103
    v_mul_f32 v79, v79, v103
    v_cvt_pk_bf16_f32 v83, v72, v76
    v_cvt_pk_bf16_f32 v87, v73, v77
    v_cvt_pk_bf16_f32 v91, v74, v78
    v_cvt_pk_bf16_f32 v95, v75, v79
    buffer_load_dwordx4 v[40:43], v110, s[20:23], s55 offen
    buffer_load_dwordx4 v[44:47], v111, s[20:23], s55 offen
    ds_write_b128 v5, v[80:83] offset:0
    ds_write_b128 v5, v[84:87] offset:2048
    ds_write_b128 v5, v[88:91] offset:4096
    ds_write_b128 v5, v[92:95] offset:6144
    v_xor_b32 v5, 16384, v5
    s_waitcnt vmcnt(8) lgkmcnt(0)
    s_barrier
    s_cmp_eq_u32 s73, 5
    s_cbranch_scc1 L_pent5
L_pent0:
    s_cmp_ge_u32 s46, 2
    s_cbranch_scc1 L_pmid0_1
    s_branch L_pmid0_0
L_ploop0_0:
    s_waitcnt vmcnt(7)
    v_fma_mix_f32 v48, v16, v8, v12 op_sel_hi:[1,0,0]
    v_fma_mix_f32 v49, v17, v9, v13 op_sel_hi:[1,0,0]
    v_fma_mix_f32 v50, v18, v10, v14 op_sel_hi:[1,0,0]
    v_fma_mix_f32 v51, v19, v11, v15 op_sel_hi:[1,0,0]
    buffer_load_dwordx4 v[16:19], v104, s[20:23], s55 offen
    v_mul_f32 v48, v48, v96
    v_mul_f32 v49, v49, v96
    v_mul_f32 v50, v50, v96
    v_mul_f32 v51, v51, v96
    s_waitcnt vmcnt(7)
    v_fma_mix_f32 v52, v20, v8, v12 op_sel_hi:[1,0,0]
    v_fma_mix_f32 v53, v21, v9, v13 op_sel_hi:[1,0,0]
    v_fma_mix_f32 v54, v22, v10, v14 op_sel_hi:[1,0,0]
    v_fma_mix_f32 v55, v23, v11, v15 op_sel_hi:[1,0,0]
    buffer_load_dwordx4 v[20:23], v105, s[20:23], s55 offen
    v_mul_f32 v52, v52, v97
    v_mul_f32 v53, v53, v97
    v_mul_f32 v54, v54, v97
    v_mul_f32 v55, v55, v97
    v_cvt_pk_bf16_f32 v80, v48, v52
    v_cvt_pk_bf16_f32 v84, v49, v53
    v_cvt_pk_bf16_f32 v88, v50, v54
    v_cvt_pk_bf16_f32 v92, v51, v55
    s_waitcnt vmcnt(7)
    v_fma_mix_f32 v56, v24, v8, v12 op_sel_hi:[1,0,0]
    v_fma_mix_f32 v57, v25, v9, v13 op_sel_hi:[1,0,0]
    v_fma_mix_f32 v58, v26, v10, v14 op_sel_hi:[1,0,0]
    v_fma_mix_f32 v59, v27, v11, v15 op_sel_hi:[1,0,0]
    buffer_load_dwordx4 v[24:27], v106, s[20:23], s55 offen
    v_mul_f32 v56, v56, v98
    v_mul_f32 v57, v57, v98
    v_mul_f32 v58, v58, v98
    v_mul_f32 v59, v59, v98
    s_waitcnt vmcnt(7)
    v_fma_mix_f32 v60, v28, v8, v12 op_sel_hi:[1,0,0]
    v_fma_mix_f32 v61, v29, v9, v13 op_sel_hi:[1,0,0]
    v_fma_mix_f32 v62, v30, v10, v14 op_sel_hi:[1,0,0]
    v_fma_mix_f32 v63, v31, v11, v15 op_sel_hi:[1,0,0]
    buffer_load_dwordx4 v[28:31], v107, s[20:23], s55 offen
    v_mul_f32 v60, v60, v99
    v_mul_f32 v61, v61, v99
    v_mul_f32 v62, v62, v99
    v_mul_f32 v63, v63, v99
    v_cvt_pk_bf16_f32 v81, v56, v60
    v_cvt_pk_bf16_f32 v85, v57, v61
    v_cvt_pk_bf16_f32 v89, v58, v62
    v_cvt_pk_bf16_f32 v93, v59, v63
    s_waitcnt vmcnt(7)
    v_fma_mix_f32 v64, v32, v8, v12 op_sel_hi:[1,0,0]
    v_fma_mix_f32 v65, v33, v9, v13 op_sel_hi:[1,0,0]
    v_fma_mix_f32 v66, v34, v10, v14 op_sel_hi:[1,0,0]
    v_fma_mix_f32 v67, v35, v11, v15 op_sel_hi:[1,0,0]
    buffer_load_dwordx4 v[32:35], v108, s[20:23], s55 offen
    v_mul_f32 v64, v64, v100
    v_mul_f32 v65, v65, v100
    v_mul_f32 v66, v66, v100
    v_mul_f32 v67, v67, v100
    s_waitcnt vmcnt(7)
    v_fma_mix_f32 v68, v36, v8, v12 op_sel_hi:[1,0,0]
    v_fma_mix_f32 v69, v37, v9, v13 op_sel_hi:[1,0,0]
    v_fma_mix_f32 v70, v38, v10, v14 op_sel_hi:[1,0,0]
    v_fma_mix_f32 v71, v39, v11, v15 op_sel_hi:[1,0,0]
    buffer_load_dwordx4 v[36:39], v109, s[20:23], s55 offen
    v_mul_f32 v68, v68, v101
    v_mul_f32 v69, v69, v101
    v_mul_f32 v70, v70, v101
    v_mul_f32 v71, v71, v101
    v_cvt_pk_bf16_f32 v82, v64, v68
    v_cvt_pk_bf16_f32 v86, v65, v69
    v_cvt_pk_bf16_f32 v90, v66, v70
    v_cvt_pk_bf16_f32 v94, v67, v71
    s_waitcnt vmcnt(7)
    v_fma_mix_f32 v72, v40, v8, v12 op_sel_hi:[1,0,0]
    v_fma_mix_f32 v73, v41, v9, v13 op_sel_hi:[1,0,0]
    v_fma_mix_f32 v74, v42, v10, v14 op_sel_hi:[1,0,0]
    v_fma_mix_f32 v75, v43, v11, v15 op_sel_hi:[1,0,0]
    buffer_load_dwordx4 v[40:43], v110, s[20:23], s55 offen
    v_mul_f32 v72, v72, v102
    v_mul_f32 v73, v73, v102
    v_mul_f32 v74, v74, v102
    v_mul_f32 v75, v75, v102
    s_waitcnt vmcnt(7)
    v_fma_mix_f32 v76, v44, v8, v12 op_sel_hi:[1,0,0]
    v_fma_mix_f32 v77, v45, v9, v13 op_sel_hi:[1,0,0]
    v_fma_mix_f32 v78, v46, v10, v14 op_sel_hi:[1,0,0]
    v_fma_mix_f32 v79, v47, v11, v15 op_sel_hi:[1,0,0]
    buffer_load_dwordx4 v[44:47], v111, s[20:23], s55 offen
    v_mul_f32 v76, v76, v103
    v_mul_f32 v77, v77, v103
    v_mul_f32 v78, v78, v103
    v_mul_f32 v79, v79, v103
    v_cvt_pk_bf16_f32 v83, v72, v76
    v_cvt_pk_bf16_f32 v87, v73, v77
    v_cvt_pk_bf16_f32 v91, v74, v78
    v_cvt_pk_bf16_f32 v95, v75, v79
    ds_write_b128 v5, v[80:83] offset:0
    ds_write_b128 v5, v[84:87] offset:2048
    ds_write_b128 v5, v[88:91] offset:4096
    ds_write_b128 v5, v[92:95] offset:6144
    v_xor_b32 v5, 16384, v5
    s_cmp_eq_u32 s56, 8
    s_cbranch_scc1 L_plast0
L_pmid0_0:
    s_lshl_b32 s50, s59, 6
    v_add_u32 v7, s50, v6
    ds_read_b128 v[96:99], v7
    ds_read_b128 v[100:103], v7 offset:16
    s_and_b32 s59, s48, 15
    s_lshr_b32 s48, s48, 4
    s_mul_i32 s55, s59, 1179648
    s_add_u32 s53, s53, 40960
    s_cmp_ge_u32 s53, s75
    s_cselect_b32 s53, s74, s53
    s_add_u32 s56, s56, 1
    s_cmp_eq_u32 s56, 8
    s_cselect_b32 s22, 0, s22
    s_waitcnt vmcnt(8) lgkmcnt(0)
    s_cmp_eq_u32 s56, 1
    s_cbranch_scc1 L_ploop0_0
    s_barrier
    s_branch L_ploop0_0
L_ploop0_1:
    s_waitcnt vmcnt(7)
    v_fma_mix_f32 v64, v32, v8, v12 op_sel_hi:[1,0,0]
    v_fma_mix_f32 v65, v33, v9, v13 op_sel_hi:[1,0,0]
    v_fma_mix_f32 v66, v34, v10, v14 op_sel_hi:[1,0,0]
    v_fma_mix_f32 v67, v35, v11, v15 op_sel_hi:[1,0,0]
    buffer_load_dwordx4 v[32:35], v108, s[20:23], s55 offen
    v_mul_f32 v64, v64, v100
    v_mul_f32 v65, v65, v100
    v_mul_f32 v66, v66, v100
    v_mul_f32 v67, v67, v100
    s_waitcnt vmcnt(7)
    v_fma_mix_f32 v68, v36, v8, v12 op_sel_hi:[1,0,0]
    v_fma_mix_f32 v69, v37, v9, v13 op_sel_hi:[1,0,0]
    v_fma_mix_f32 v70, v38, v10, v14 op_sel_hi:[1,0,0]
    v_fma_mix_f32 v71, v39, v11, v15 op_sel_hi:[1,0,0]
    buffer_load_dwordx4 v[36:39], v109, s[20:23], s55 offen
    v_mul_f32 v68, v68, v101
    v_mul_f32 v69, v69, v101
    v_mul_f32 v70, v70, v101
    v_mul_f32 v71, v71, v101
    v_cvt_pk_bf16_f32 v82, v64, v68
    v_cvt_pk_bf16_f32 v86, v65, v69
    v_cvt_pk_bf16_f32 v90, v66, v70
    v_cvt_pk_bf16_f32 v94, v67, v71
    s_waitcnt vmcnt(7)
    v_fma_mix_f32 v72, v40, v8, v12 op_sel_hi:[1,0,0]
    v_fma_mix_f32 v73, v41, v9, v13 op_sel_hi:[1,0,0]
    v_fma_mix_f32 v74, v42, v10, v14 op_sel_hi:[1,0,0]
    v_fma_mix_f32 v75, v43, v11, v15 op_sel_hi:[1,0,0]
    buffer_load_dwordx4 v[40:43], v110, s[20:23], s55 offen
    v_mul_f32 v72, v72, v102
    v_mul_f32 v73, v73, v102
    v_mul_f32 v74, v74, v102
    v_mul_f32 v75, v75, v102
    s_waitcnt vmcnt(7)
    v_fma_mix_f32 v76, v44, v8, v12 op_sel_hi:[1,0,0]
    v_fma_mix_f32 v77, v45, v9, v13 op_sel_hi:[1,0,0]
    v_fma_mix_f32 v78, v46, v10, v14 op_sel_hi:[1,0,0]
    v_fma_mix_f32 v79, v47, v11, v15 op_sel_hi:[1,0,0]
    buffer_load_dwordx4 v[44:47], v111, s[20:23], s55 offen
    v_mul_f32 v76, v76, v103
    v_mul_f32 v77, v77, v103
    v_mul_f32 v78, v78, v103
    v_mul_f32 v79, v79, v103
    v_cvt_pk_bf16_f32 v83, v72, v76
    v_cvt_pk_bf16_f32 v87, v73, v77
    v_cvt_pk_bf16_f32 v91, v74, v78
    v_cvt_pk_bf16_f32 v95, v75, v79
    ds_write_b128 v5, v[80:83] offset:0
    ds_write_b128 v5, v[84:87] offset:2048
    ds_write_b128 v5, v[88:91] offset:4096
    ds_write_b128 v5, v[92:95] offset:6144
    v_xor_b32 v5, 16384, v5
    s_cmp_eq_u32 s56, 8
    s_cbranch_scc1 L_plast0
L_pmid0_1:
    s_lshl_b32 s50, s59, 6
    v_add_u32 v7, s50, v6
    ds_read_b128 v[96:99], v7
    ds_read_b128 v[100:103], v7 offset:16
    s_and_b32 s59, s48, 15
    s_lshr_b32 s48, s48, 4
    s_mul_i32 s55, s59, 1179648
    s_add_u32 s53, s53, 40960
    s_cmp_ge_u32 s53, s75
    s_cselect_b32 s53, s74, s53
    s_add_u32 s56, s56, 1
    s_cmp_eq_u32 s56, 8
    s_cselect_b32 s22, 0, s22
    s_waitcnt vmcnt(7)
    v_fma_mix_f32 v48, v16, v8, v12 op_sel_hi:[1,0,0]
    v_fma_mix_f32 v49, v17, v9, v13 op_sel_hi:[1,0,0]
    v_fma_mix_f32 v50, v18, v10, v14 op_sel_hi:[1,0,0]
    v_fma_mix_f32 v51, v19, v11, v15 op_sel_hi:[1,0,0]
    buffer_load_dwordx4 v[16:19], v104, s[20:23], s55 offen
    s_waitcnt lgkmcnt(0)
    v_mul_f32 v48, v48, v96
    v_mul_f32 v49, v49, v96
    v_mul_f32 v50, v50, v96
    v_mul_f32 v51, v51, v96
    s_waitcnt vmcnt(7)
    v_fma_mix_f32 v52, v20, v8, v12 op_sel_hi:[1,0,0]
    v_fma_mix_f32 v53, v21, v9, v13 op_sel_hi:[1,0,0]
    v_fma_mix_f32 v54, v22, v10, v14 op_sel_hi:[1,0,0]
    v_fma_mix_f32 v55, v23, v11, v15 op_sel_hi:[1,0,0]
    buffer_load_dwordx4 v[20:23], v105, s[20:23], s55 offen
    v_mul_f32 v52, v52, v97
    v_mul_f32 v53, v53, v97
    v_mul_f32 v54, v54, v97
    v_mul_f32 v55, v55, v97
    v_cvt_pk_bf16_f32 v80, v48, v52
    v_cvt_pk_bf16_f32 v84, v49, v53
    v_cvt_pk_bf16_f32 v88, v50, v54
    v_cvt_pk_bf16_f32 v92, v51, v55
    s_waitcnt vmcnt(7)
    v_fma_mix_f32 v56, v24, v8, v12 op_sel_hi:[1,0,0]
    v_fma_mix_f32 v57, v25, v9, v13 op_sel_hi:[1,0,0]
    v_fma_mix_f32 v58, v26, v10, v14 op_sel_hi:[1,0,0]
    v_fma_mix_f32 v59, v27, v11, v15 op_sel_hi:[1,0,0]
    buffer_load_dwordx4 v[24:27], v106, s[20:23], s55 offen
    v_mul_f32 v56, v56, v98
    v_mul_f32 v57, v57, v98
    v_mul_f32 v58, v58, v98
    v_mul_f32 v59, v59, v98
    s_waitcnt vmcnt(7)
    v_fma_mix_f32 v60, v28, v8, v12 op_sel_hi:[1,0,0]
    v_fma_mix_f32 v61, v29, v9, v13 op_sel_hi:[1,0,0]
    v_fma_mix_f32 v62, v30, v10, v14 op_sel_hi:[1,0,0]
    v_fma_mix_f32 v63, v31, v11, v15 op_sel_hi:[1,0,0]
    buffer_load_dwordx4 v[28:31], v107, s[20:23], s55 offen
    v_mul_f32 v60, v60, v99
    v_mul_f32 v61, v61, v99
    v_mul_f32 v62, v62, v99
    v_mul_f32 v63, v63, v99
    v_cvt_pk_bf16_f32 v81, v56, v60
    v_cvt_pk_bf16_f32 v85, v57, v61
    v_cvt_pk_bf16_f32 v89, v58, v62
    v_cvt_pk_bf16_f32 v93, v59, v63
    s_waitcnt vmcnt(12) lgkmcnt(0)
    s_cmp_eq_u32 s56, 1
    s_cbranch_scc1 L_ploop0_1
    s_barrier
    s_branch L_ploop0_1
L_plast0:
    s_waitcnt vmcnt(8)
    s_branch L_last
L_pent5:
    s_mov_b32 m0, s53
    s_lshl_b32 s52, s59, 7
    buffer_load_dwordx4 v112, s[16:19], s52 offen lds
    s_add_u32 m0, m0, 1024
    s_add_u32 s52, s52, 9216
    buffer_load_dwordx4 v113, s[16:19], s52 offen lds
    s_add_u32 m0, m0, 1024
    s_add_u32 s52, s52, 9216
    buffer_load_dwordx4 v112, s[16:19], s52 offen lds
    s_add_u32 m0, m0, 1024
    s_add_u32 s52, s52, 9216
    buffer_load_dwordx4 v113, s[16:19], s52 offen lds
    s_add_u32 m0, m0, 1024
    s_add_u32 s52, s52, 9216
    buffer_load_dwordx4 v112, s[16:19], s52 offen lds
    s_cmp_ge_u32 s46, 2
    s_cbranch_scc1 L_pmid5_1
    s_branch L_pmid5_0
L_ploop5_0:
    s_waitcnt vmcnt(12)
    v_fma_mix_f32 v48, v16, v8, v12 op_sel_hi:[1,0,0]
    v_fma_mix_f32 v49, v17, v9, v13 op_sel_hi:[1,0,0]
    v_fma_mix_f32 v50, v18, v10, v14 op_sel_hi:[1,0,0]
    v_fma_mix_f32 v51, v19, v11, v15 op_sel_hi:[1,0,0]
    buffer_load_dwordx4 v[16:19], v104, s[20:23], s55 offen
    v_mul_f32 v48, v48, v96
    v_mul_f32 v49, v49, v96
    v_mul_f32 v50, v50, v96
    v_mul_f32 v51, v51, v96
    s_waitcnt vmcnt(12)
    v_fma_mix_f32 v52, v20, v8, v12 op_sel_hi:[1,0,0]
    v_fma_mix_f32 v53, v21, v9, v13 op_sel_hi:[1,0,0]
    v_fma_mix_f32 v54, v22, v10, v14 op_sel_hi:[1,0,0]
    v_fma_mix_f32 v55, v23, v11, v15 op_sel_hi:[1,0,0]
    buffer_load_dwordx4 v[20:23], v105, s[20:23], s55 offen
    v_mul_f32 v52, v52, v97
    v_mul_f32 v53, v53, v97
    s_mov_b32 m0, s53
    s_lshl_b32 s52, s59, 7
    v_mul_f32 v54, v54, v97
    v_mul_f32 v55, v55, v97
    buffer_load_dwordx4 v112, s[16:19], s52 offen lds
    v_cvt_pk_bf16_f32 v80, v48, v52
    v_cvt_pk_bf16_f32 v84, v49, v53
    v_cvt_pk_bf16_f32 v88, v50, v54
    v_cvt_pk_bf16_f32 v92, v51, v55
    s_waitcnt vmcnt(12)
    v_fma_mix_f32 v56, v24, v8, v12 op_sel_hi:[1,0,0]
    v_fma_mix_f32 v57, v25, v9, v13 op_sel_hi:[1,0,0]
    v_fma_mix_f32 v58, v26, v10, v14 op_sel_hi:[1,0,0]
    v_fma_mix_f32 v59, v27, v11, v15 op_sel_hi:[1,0,0]
    buffer_load_dwordx4 v[24:27], v106, s[20:23], s55 offen
    v_mul_f32 v56, v56, v98
    v_mul_f32 v57, v57, v98
    v_mul_f32 v58, v58, v98
    v_mul_f32 v59, v59, v98
    s_waitcnt vmcnt(12)
    v_fma_mix_f32 v60, v28, v8, v12 op_sel_hi:[1,0,0]
    v_fma_mix_f32 v61, v29, v9, v13 op_sel_hi:[1,0,0]
    v_fma_mix_f32 v62, v30, v10, v14 op_sel_hi:[1,0,0]
    v_fma_mix_f32 v63, v31, v11, v15 op_sel_hi:[1,0,0]
    buffer_load_dwordx4 v[28:31], v107, s[20:23], s55 offen
    v_mul_f32 v60, v60, v99
    v_mul_f32 v61, v61, v99
    s_add_u32 m0, m0, 1024
    s_add_u32 s52, s52, 9216
    v_mul_f32 v62, v62, v99
    v_mul_f32 v63, v63, v99
    buffer_load_dwordx4 v113, s[16:19], s52 offen lds
    v_cvt_pk_bf16_f32 v81, v56, v60
    v_cvt_pk_bf16_f32 v85, v57, v61
    v_cvt_pk_bf16_f32 v89, v58, v62
    v_cvt_pk_bf16_f32 v93, v59, v63
    s_waitcnt vmcnt(12)
    v_fma_mix_f32 v64, v32, v8, v12 op_sel_hi:[1,0,0]
    v_fma_mix_f32 v65, v33, v9, v13 op_sel_hi:[1,0,0]
    v_fma_mix_f32 v66, v34, v10, v14 op_sel_hi:[1,0,0]
    v_fma_mix_f32 v67, v35, v11, v15 op_sel_hi:[1,0,0]
    buffer_load_dwordx4 v[32:35], v108, s[20:23], s55 offen
    v_mul_f32 v64, v64, v100
    v_mul_f32 v65, v65, v100
    v_mul_f32 v66, v66, v100
    v_mul_f32 v67, v67, v100
    s_waitcnt vmcnt(12)
    v_fma_mix_f32 v68, v36, v8, v12 op_sel_hi:[1,0,0]
    v_fma_mix_f32 v69, v37, v9, v13 op_sel_hi:[1,0,0]
    v_fma_mix_f32 v70, v38, v10, v14 op_sel_hi:[1,0,0]
    v_fma_mix_f32 v71, v39, v11, v15 op_sel_hi:[1,0,0]
    buffer_load_dwordx4 v[36:39], v109, s[20:23], s55 offen
    v_mul_f32 v68, v68, v101
    v_mul_f32 v69, v69, v101
    v_mul_f32 v70, v70, v101
    v_mul_f32 v71, v71, v101
    v_cvt_pk_bf16_f32 v82, v64, v68
    v_cvt_pk_bf16_f32 v86, v65, v69
    v_cvt_pk_bf16_f32 v90, v66, v70
    v_cvt_pk_bf16_f32 v94, v67, v71
    s_waitcnt vmcnt(12)
    v_fma_mix_f32 v72, v40, v8, v12 op_sel_hi:[1,0,0]
    v_fma_mix_f32 v73, v41, v9, v13 op_sel_hi:[1,0,0]
    v_fma_mix_f32 v74, v42, v10, v14 op_sel_hi:[1,0,0]
    v_fma_mix_f32 v75, v43, v11, v15 op_sel_hi:[1,0,0]
    buffer_load_dwordx4 v[40:43], v110, s[20:23], s55 offen
    v_mul_f32 v72, v72, v102
    v_mul_f32 v73, v73, v102
    s_add_u32 m0, m0, 1024
    s_add_u32 s52, s52, 9216
    v_mul_f32 v74, v74, v102
    v_mul_f32 v75, v75, v102
    buffer_load_dwordx4 v112, s[16:19], s52 offen lds
    s_waitcnt vmcnt(12)
    v_fma_mix_f32 v76, v44, v8, v12 op_sel_hi:[1,0,0]
    v_fma_mix_f32 v77, v45, v9, v13 op_sel_hi:[1,0,0]
    v_fma_mix_f32 v78, v46, v10, v14 op_sel_hi:[1,0,0]
    v_fma_mix_f32 v79, v47, v11, v15 op_sel_hi:[1,0,0]
    buffer_load_dwordx4 v[44:47], v111, s[20:23], s55 offen
    v_mul_f32 v76, v76, v103
    v_mul_f32 v77, v77, v103
    v_mul_f32 v78, v78, v103
    v_mul_f32 v79, v79, v103
    v_cvt_pk_bf16_f32 v83, v72, v76
    v_cvt_pk_bf16_f32 v87, v73, v77
    v_cvt_pk_bf16_f32 v91, v74, v78
    v_cvt_pk_bf16_f32 v95, v75, v79
    ds_write_b128 v5, v[80:83] offset:0
    s_add_u32 m0, m0, 1024
    s_add_u32 s52, s52, 9216
    buffer_load_dwordx4 v113, s[16:19], s52 offen lds
    ds_write_b128 v5, v[84:87] offset:2048
    ds_write_b128 v5, v[88:91] offset:4096
    s_add_u32 m0, m0, 1024
    s_add_u32 s52, s52, 9216
    buffer_load_dwordx4 v112, s[16:19], s52 offen lds
    ds_write_b128 v5, v[92:95] offset:6144
    v_xor_b32 v5, 16384, v5
    s_cmp_eq_u32 s56, 8
    s_cbranch_scc1 L_plast5
L_pmid5_0:
    s_lshl_b32 s50, s59, 6
    v_add_u32 v7, s50, v6
    ds_read_b128 v[96:99], v7
    ds_read_b128 v[100:103], v7 offset:16
    s_and_b32 s59, s48, 15
    s_lshr_b32 s48, s48, 4
    s_mul_i32 s55, s59, 1179648
    s_add_u32 s53, s53, 40960
    s_cmp_ge_u32 s53, s75
    s_cselect_b32 s53, s74, s53
    s_add_u32 s56, s56, 1
    s_cmp_eq_u32 s56, 8
    s_cselect_b32 s22, 0, s22
    s_cselect_b32 s18, 0, s18
    s_waitcnt vmcnt(13) lgkmcnt(0)
    s_cmp_eq_u32 s56, 1
    s_cbranch_scc1 L_ploop5_0
    s_barrier
    s_branch L_ploop5_0
L_ploop5_1:
    s_waitcnt vmcnt(12)
    v_fma_mix_f32 v64, v32, v8, v12 op_sel_hi:[1,0,0]
    v_fma_mix_f32 v65, v33, v9, v13 op_sel_hi:[1,0,0]
    v_fma_mix_f32 v66, v34, v10, v14 op_sel_hi:[1,0,0]
    v_fma_mix_f32 v67, v35, v11, v15 op_sel_hi:[1,0,0]
    buffer_load_dwordx4 v[32:35], v108, s[20:23], s55 offen
    v_mul_f32 v64, v64, v100
    v_mul_f32 v65, v65, v100
    s_mov_b32 m0, s53
    s_lshl_b32 s52, s59, 7
    v_mul_f32 v66, v66, v100
    v_mul_f32 v67, v67, v100
    buffer_load_dwordx4 v112, s[16:19], s52 offen lds
    s_waitcnt vmcnt(12)
    v_fma_mix_f32 v68, v36, v8, v12 op_sel_hi:[1,0,0]
    v_fma_mix_f32 v69, v37, v9, v13 op_sel_hi:[1,0,0]
    v_fma_mix_f32 v70, v38, v10, v14 op_sel_hi:[1,0,0]
    v_fma_mix_f32 v71, v39, v11, v15 op_sel_hi:[1,0,0]
    buffer_load_dwordx4 v[36:39], v109, s[20:23], s55 offen
    v_mul_f32 v68, v68, v101
    v_mul_f32 v69, v69, v101
    v_mul_f32 v70, v70, v101
    v_mul_f32 v71, v71, v101
    v_cvt_pk_bf16_f32 v82, v64, v68
    v_cvt_pk_bf16_f32 v86, v65, v69
    v_cvt_pk_bf16_f32 v90, v66, v70
    v_cvt_pk_bf16_f32 v94, v67, v71
    s_waitcnt vmcnt(12)
    v_fma_mix_f32 v72, v40, v8, v12 op_sel_hi:[1,0,0]
    v_fma_mix_f32 v73, v41, v9, v13 op_sel_hi:[1,0,0]
    v_fma_mix_f32 v74, v42, v10, v14 op_sel_hi:[1,0,0]
    v_fma_mix_f32 v75, v43, v11, v15 op_sel_hi:[1,0,0]
    buffer_load_dwordx4 v[40:43], v110, s[20:23], s55 offen
    v_mul_f32 v72, v72, v102
    v_mul_f32 v73, v73, v102
    s_add_u32 m0, m0, 1024
    s_add_u32 s52, s52, 9216
    v_mul_f32 v74, v74, v102
    v_mul_f32 v75, v75, v102
    buffer_load_dwordx4 v113, s[16:19], s52 offen lds
    s_waitcnt vmcnt(12)
    v_fma_mix_f32 v76, v44, v8, v12 op_sel_hi:[1,0,0]
    v_fma_mix_f32 v77, v45, v9, v13 op_sel_hi:[1,0,0]
    v_fma_mix_f32 v78, v46, v10, v14 op_sel_hi:[1,0,0]
    v_fma_mix_f32 v79, v47, v11, v15 op_sel_hi:[1,0,0]
    buffer_load_dwordx4 v[44:47], v111, s[20:23], s55 offen
    v_mul_f32 v76, v76, v103
    v_mul_f32 v77, v77, v103
    v_mul_f32 v78, v78, v103
    v_mul_f32 v79, v79, v103
    v_cvt_pk_bf16_f32 v83, v72, v76
    v_cvt_pk_bf16_f32 v87, v73, v77
    v_cvt_pk_bf16_f32 v91, v74, v78
    v_cvt_pk_bf16_f32 v95, v75, v79
    ds_write_b128 v5, v[80:83] offset:0
    s_add_u32 m0, m0, 1024
    s_add_u32 s52, s52, 9216
    buffer_load_dwordx4 v112, s[16:19], s52 offen lds
    ds_write_b128 v5, v[84:87] offset:2048
    s_add_u32 m0, m0, 1024
    s_add_u32 s52, s52, 9216
    buffer_load_dwordx4 v113, s[16:19], s52 offen lds
    ds_write_b128 v5, v[88:91] offset:4096
    ds_write_b128 v5, v[92:95] offset:6144
    s_add_u32 m0, m0, 1024
    s_add_u32 s52, s52, 9216
    buffer_load_dwordx4 v112, s[16:19], s52 offen lds
    v_xor_b32 v5, 16384, v5
    s_cmp_eq_u32 s56, 8
    s_cbranch_scc1 L_plast5
L_pmid5_1:
    s_lshl_b32 s50, s59, 6
    v_add_u32 v7, s50, v6
    ds_read_b128 v[96:99], v7
    ds_read_b128 v[100:103], v7 offset:16
    s_and_b32 s59, s48, 15
    s_lshr_b32 s48, s48, 4
    s_mul_i32 s55, s59, 1179648
    s_add_u32 s53, s53, 40960
    s_cmp_ge_u32 s53, s75
    s_cselect_b32 s53, s74, s53
    s_add_u32 s56, s56, 1
    s_cmp_eq_u32 s56, 8
    s_cselect_b32 s22, 0, s22
    s_cselect_b32 s18, 0, s18
    s_waitcnt vmcnt(12)
    v_fma_mix_f32 v48, v16, v8, v12 op_sel_hi:[1,0,0]
    v_fma_mix_f32 v49, v17, v9, v13 op_sel_hi:[1,0,0]
    v_fma_mix_f32 v50, v18, v10, v14 op_sel_hi:[1,0,0]
    v_fma_mix_f32 v51, v19, v11, v15 op_sel_hi:[1,0,0]
    buffer_load_dwordx4 v[16:19], v104, s[20:23], s55 offen
    s_waitcnt lgkmcnt(0)
    v_mul_f32 v48, v48, v96
    v_mul_f32 v49, v49, v96
    v_mul_f32 v50, v50, v96
    v_mul_f32 v51, v51, v96
    s_waitcnt vmcnt(12)
    v_fma_mix_f32 v52, v20, v8, v12 op_sel_hi:[1,0,0]
    v_fma_mix_f32 v53, v21, v9, v13 op_sel_hi:[1,0,0]
    v_fma_mix_f32 v54, v22, v10, v14 op_sel_hi:[1,0,0]
    v_fma_mix_f32 v55, v23, v11, v15 op_sel_hi:[1,0,0]
    buffer_load_dwordx4 v[20:23], v105, s[20:23], s55 offen
    v_mul_f32 v52, v52, v97
    v_mul_f32 v53, v53, v97
    v_mul_f32 v54, v54, v97
    v_mul_f32 v55, v55, v97
    v_cvt_pk_bf16_f32 v80, v48, v52
    v_cvt_pk_bf16_f32 v84, v49, v53
    v_cvt_pk_bf16_f32 v88, v50, v54
    v_cvt_pk_bf16_f32 v92, v51, v55
    s_waitcnt vmcnt(12)
    v_fma_mix_f32 v56, v24, v8, v12 op_sel_hi:[1,0,0]
    v_fma_mix_f32 v57, v25, v9, v13 op_sel_hi:[1,0,0]
    v_fma_mix_f32 v58, v26, v10, v14 op_sel_hi:[1,0,0]
    v_fma_mix_f32 v59, v27, v11, v15 op_sel_hi:[1,0,0]
    buffer_load_dwordx4 v[24:27], v106, s[20:23], s55 offen
    v_mul_f32 v56, v56, v98
    v_mul_f32 v57, v57, v98
    v_mul_f32 v58, v58, v98
    v_mul_f32 v59, v59, v98
    s_waitcnt vmcnt(12)
    v_fma_mix_f32 v60, v28, v8, v12 op_sel_hi:[1,0,0]
    v_fma_mix_f32 v61, v29, v9, v13 op_sel_hi:[1,0,0]
    v_fma_mix_f32 v62, v30, v10, v14 op_sel_hi:[1,0,0]
    v_fma_mix_f32 v63, v31, v11, v15 op_sel_hi:[1,0,0]
    buffer_load_dwordx4 v[28:31], v107, s[20:23], s55 offen
    v_mul_f32 v60, v60, v99
    v_mul_f32 v61, v61, v99
    v_mul_f32 v62, v62, v99
    v_mul_f32 v63, v63, v99
    v_cvt_pk_bf16_f32 v81, v56, v60
    v_cvt_pk_bf16_f32 v85, v57, v61
    v_cvt_pk_bf16_f32 v89, v58, v62
    v_cvt_pk_bf16_f32 v93, v59, v63
    s_waitcnt vmcnt(17) lgkmcnt(0)
    s_cmp_eq_u32 s56, 1
    s_cbranch_scc1 L_ploop5_1
    s_barrier
    s_branch L_ploop5_1
L_plast5:
    s_waitcnt vmcnt(13)
    s_branch L_last
L_last:
    s_waitcnt lgkmcnt(0)
    s_barrier
    s_add_u32 s46, s46, 4
    s_branch L_end
L_consumer:
    s_mov_b32 s38, 18874368
    s_mov_b32 s39, 0x20000
    s_mov_b32 s72, 8
    s_cmp_eq_u32 s47, 10
    s_cselect_b32 s72, 5, s72
    s_mul_i32 s54, s46, s72
    s_lshl_b32 s51, s54, 2
    s_lshl_b32 s50, s54, 3
    s_add_u32 s50, s50, s45
    v_lshrrev_b32 v12, 3, v1
    v_add_u32 v12, s50, v12
    v_mul_u32_u24 v12, 1152, v12
    v_lshrrev_b32 v13, 4, v1
    v_add_u32 v13, s51, v13
    v_xor_b32 v13, v13, v1
    v_and_b32 v13, 7, v13
    v_lshl_add_u32 v8, v13, 4, v12
    v_xor_b32 v9, 64, v8
    s_lshl_b32 s53, s54, 10
    s_add_u32 s74, s53, 36864
    s_add_u32 s75, s74, 122880
    s_add_u32 s53, s74, 40960
    s_and_b32 s59, s48, 15
    s_lshr_b32 s48, s48, 4
    s_mul_i32 s71, s46, s47
    s_lshl_b32 s71, s71, 3
    v_and_b32 v12, 15, v1
    v_lshrrev_b32 v13, 4, v1
    v_lshrrev_b32 v14, 1, v12
    v_xor_b32 v15, v13, v14
    s_lshl_b32 s50, s71, 7
    s_add_u32 s50, s50, 36864
    v_lshlrev_b32 v10, 7, v12
    v_lshl_add_u32 v10, v15, 4, v10
    s_mov_b32 s76, s50
    s_add_u32 s77, s50, 122880
    s_mov_b32 s57, s50
    v_add_u32 v3, s50, v10
    v_xor_b32 v4, 64, v3
    v_and_b32 v14, 1, v12
    v_lshlrev_b32 v14, 1, v14
    v_xor_b32 v15, v15, v14
    v_lshlrev_b32 v5, 7, v12
    v_lshl_add_u32 v5, v15, 4, v5
    v_xor_b32 v6, 64, v5
    s_add_u32 s50, s71, s45
    v_lshl_add_u32 v7, v13, 2, s50
    v_mul_u32_u24 v7, 9216, v7
    v_lshl_add_u32 v7, v12, 4, v7
    s_lshl_b32 s50, s44, 8
    v_add_u32 v7, s50, v7
    v_mov_b32 v96, 0
    v_mov_b32 v97, 0
    v_mov_b32 v98, 0
    v_mov_b32 v99, 0
    v_mov_b32 v100, 0
    v_mov_b32 v101, 0
    v_mov_b32 v102, 0
    v_mov_b32 v103, 0
    v_mov_b32 v104, 0
    v_mov_b32 v105, 0
    v_mov_b32 v106, 0
    v_mov_b32 v107, 0
    v_mov_b32 v108, 0
    v_mov_b32 v109, 0
    v_mov_b32 v110, 0
    v_mov_b32 v111, 0
    v_mov_b32 v112, 0
    v_mov_b32 v113, 0
    v_mov_b32 v114, 0
    v_mov_b32 v115, 0
    v_mov_b32 v116, 0
    v_mov_b32 v117, 0
    v_mov_b32 v118, 0
    v_mov_b32 v119, 0
    v_mov_b32 v120, 0
    v_mov_b32 v121, 0
    v_mov_b32 v122, 0
    v_mov_b32 v123, 0
    v_mov_b32 v124, 0
    v_mov_b32 v125, 0
    v_mov_b32 v126, 0
    v_mov_b32 v127, 0
    v_mov_b32 v128, 0
    v_mov_b32 v129, 0
    v_mov_b32 v130, 0
    v_mov_b32 v131, 0
    v_mov_b32 v132, 0
    v_mov_b32 v133, 0
    v_mov_b32 v134, 0
    v_mov_b32 v135, 0
    v_mov_b32 v136, 0
    v_mov_b32 v137, 0
    v_mov_b32 v138, 0
    v_mov_b32 v139, 0
    v_mov_b32 v140, 0
    v_mov_b32 v141, 0
    v_mov_b32 v142, 0
    v_mov_b32 v143, 0
    v_mov_b32 v144, 0
    v_mov_b32 v145, 0
    v_mov_b32 v146, 0
    v_mov_b32 v147, 0
    v_mov_b32 v148, 0
    v_mov_b32 v149, 0
    v_mov_b32 v150, 0
    v_mov_b32 v151, 0
    v_mov_b32 v152, 0
    v_mov_b32 v153, 0
    v_mov_b32 v154, 0
    v_mov_b32 v155, 0
    v_mov_b32 v156, 0
    v_mov_b32 v157, 0
    v_mov_b32 v158, 0
    v_mov_b32 v159, 0
    v_mov_b32 v160, 0
    v_mov_b32 v161, 0
    v_mov_b32 v162, 0
    v_mov_b32 v163, 0
    v_mov_b32 v164, 0
    v_mov_b32 v165, 0
    v_mov_b32 v166, 0
    v_mov_b32 v167, 0
    v_mov_b32 v168, 0
    v_mov_b32 v169, 0
    v_mov_b32 v170, 0
    v_mov_b32 v171, 0
    v_mov_b32 v172, 0
    v_mov_b32 v173, 0
    v_mov_b32 v174, 0
    v_mov_b32 v175, 0
    v_mov_b32 v176, 0
    v_mov_b32 v177, 0
    v_mov_b32 v178, 0
    v_mov_b32 v179, 0
    v_mov_b32 v180, 0
    v_mov_b32 v181, 0
    v_mov_b32 v182, 0
    v_mov_b32 v183, 0
    v_mov_b32 v184, 0
    v_mov_b32 v185, 0
    v_mov_b32 v186, 0
    v_mov_b32 v187, 0
    v_mov_b32 v188, 0
    v_mov_b32 v189, 0
    v_mov_b32 v190, 0
    v_mov_b32 v191, 0
    v_mov_b32 v192, 0
    v_mov_b32 v193, 0
    v_mov_b32 v194, 0
    v_mov_b32 v195, 0
    v_mov_b32 v196, 0
    v_mov_b32 v197, 0
    v_mov_b32 v198, 0
    v_mov_b32 v199, 0
    v_mov_b32 v200, 0
    v_mov_b32 v201, 0
    v_mov_b32 v202, 0
    v_mov_b32 v203, 0
    v_mov_b32 v204, 0
    v_mov_b32 v205, 0
    v_mov_b32 v206, 0
    v_mov_b32 v207, 0
    v_mov_b32 v208, 0
    v_mov_b32 v209, 0
    v_mov_b32 v210, 0
    v_mov_b32 v211, 0
    v_mov_b32 v212, 0
    v_mov_b32 v213, 0
    v_mov_b32 v214, 0
    v_mov_b32 v215, 0
    v_mov_b32 v216, 0
    v_mov_b32 v217, 0
    v_mov_b32 v218, 0
    v_mov_b32 v219, 0
    v_mov_b32 v220, 0
    v_mov_b32 v221, 0
    v_mov_b32 v222, 0
    v_mov_b32 v223, 0
    v_mov_b32 v224, 0
    v_mov_b32 v225, 0
    v_mov_b32 v226, 0
    v_mov_b32 v227, 0
    v_mov_b32 v228, 0
    v_mov_b32 v229, 0
    v_mov_b32 v230, 0
    v_mov_b32 v231, 0
    v_mov_b32 v232, 0
    v_mov_b32 v233, 0
    v_mov_b32 v234, 0
    v_mov_b32 v235, 0
    v_mov_b32 v236, 0
    v_mov_b32 v237, 0
    v_mov_b32 v238, 0
    v_mov_b32 v239, 0
    v_mov_b32 v240, 0
    v_mov_b32 v241, 0
    v_mov_b32 v242, 0
    v_mov_b32 v243, 0
    v_mov_b32 v244, 0
    v_mov_b32 v245, 0
    v_mov_b32 v246, 0
    v_mov_b32 v247, 0
    v_mov_b32 v248, 0
    v_mov_b32 v249, 0
    v_mov_b32 v250, 0
    v_mov_b32 v251, 0
    v_mov_b32 v252, 0
    v_mov_b32 v253, 0
    v_mov_b32 v254, 0
    v_mov_b32 v255, 0
    s_mov_b32 s56, 0
    s_waitcnt vmcnt(0) lgkmcnt(0)
    s_cmp_eq_u32 s47, 10
    s_cbranch_scc1 L_cons10
L_cons8:
    s_barrier
    ds_read_b128 v[56:59], v5 offset:0
    ds_read_b128 v[16:19], v3 offset:0
    ds_read_b128 v[60:63], v5 offset:2048
    ds_read_b128 v[64:67], v5 offset:4096
    ds_read_b128 v[20:23], v3 offset:2048
    ds_read_b128 v[24:27], v3 offset:4096
    ds_read_b128 v[28:31], v3 offset:6144
    ds_read_b128 v[68:71], v5 offset:6144
    ds_read_b128 v[72:75], v6 offset:8192
    ds_read_b128 v[76:79], v6 offset:10240
    ds_read_b128 v[80:83], v6 offset:12288
    ds_read_b128 v[84:87], v6 offset:14336
    s_mov_b32 m0, s53
    s_lshl_b32 s52, s59, 7
    buffer_load_dwordx4 v8, s[16:19], s52 offen lds
    s_add_u32 m0, m0, 1024
    s_add_u32 s52, s52, 9216
    buffer_load_dwordx4 v9, s[16:19], s52 offen lds
    s_add_u32 m0, m0, 1024
    s_add_u32 s52, s52, 9216
    buffer_load_dwordx4 v8, s[16:19], s52 offen lds
    s_add_u32 m0, m0, 1024
    s_add_u32 s52, s52, 9216
    buffer_load_dwordx4 v9, s[16:19], s52 offen lds
    s_add_u32 m0, m0, 1024
    s_add_u32 s52, s52, 9216
    buffer_load_dwordx4 v8, s[16:19], s52 offen lds
    s_add_u32 m0, m0, 1024
    s_add_u32 s52, s52, 9216
    buffer_load_dwordx4 v9, s[16:19], s52 offen lds
    s_add_u32 m0, m0, 1024
    s_add_u32 s52, s52, 9216
    buffer_load_dwordx4 v8, s[16:19], s52 offen lds
    s_add_u32 m0, m0, 1024
    s_add_u32 s52, s52, 9216
    buffer_load_dwordx4 v9, s[16:19], s52 offen lds
    s_and_b32 s59, s48, 15
    s_lshr_b32 s48, s48, 4
    s_add_u32 s53, s53, 40960
    s_cmp_ge_u32 s53, s75
    s_cselect_b32 s53, s74, s53
L_cmid8:
    s_waitcnt lgkmcnt(5)
    v_mfma_f32_16x16x32_bf16 v[96:99], v[16:19], v[56:59], v[96:99]
    s_cmp_eq_u32 s56, 7
    s_cselect_b32 s18, 0, s18
    v_mfma_f32_16x16x32_bf16 v[128:131], v[20:23], v[56:59], v[128:131]
    s_mov_b32 m0, s53
    s_lshl_b32 s52, s59, 7
    v_mfma_f32_16x16x32_bf16 v[160:163], v[24:27], v[56:59], v[160:163]
    buffer_load_dwordx4 v8, s[16:19], s52 offen lds
    s_add_u32 m0, m0, 1024
    v_mfma_f32_16x16x32_bf16 v[192:195], v[28:31], v[56:59], v[192:195]
    ds_read_b128 v[56:59], v6 offset:0
    v_mfma_f32_16x16x32_bf16 v[100:103], v[16:19], v[60:63], v[100:103]
    ds_read_b128 v[36:39], v4 offset:0
    s_add_u32 s52, s52, 9216
    v_mfma_f32_16x16x32_bf16 v[132:135], v[20:23], v[60:63], v[132:135]
    v_mfma_f32_16x16x32_bf16 v[164:167], v[24:27], v[60:63], v[164:167]
    v_mfma_f32_16x16x32_bf16 v[196:199], v[28:31], v[60:63], v[196:199]
    ds_read_b128 v[60:63], v6 offset:2048
    v_mfma_f32_16x16x32_bf16 v[104:107], v[16:19], v[64:67], v[104:107]
    ds_read_b128 v[40:43], v4 offset:2048
    v_mfma_f32_16x16x32_bf16 v[136:139], v[20:23], v[64:67], v[136:139]
    buffer_load_dwordx4 v9, s[16:19], s52 offen lds
    s_add_u32 m0, m0, 1024
    v_mfma_f32_16x16x32_bf16 v[168:171], v[24:27], v[64:67], v[168:171]
    s_add_u32 s52, s52, 9216
    v_mfma_f32_16x16x32_bf16 v[200:203], v[28:31], v[64:67], v[200:203]
    ds_read_b128 v[64:67], v6 offset:4096
    s_waitcnt lgkmcnt(9)
    v_mfma_f32_16x16x32_bf16 v[108:111], v[16:19], v[68:71], v[108:111]
    ds_read_b128 v[44:47], v4 offset:4096
    v_mfma_f32_16x16x32_bf16 v[140:143], v[20:23], v[68:71], v[140:143]
    v_mfma_f32_16x16x32_bf16 v[172:175], v[24:27], v[68:71], v[172:175]
    v_mfma_f32_16x16x32_bf16 v[204:207], v[28:31], v[68:71], v[204:207]
    ds_read_b128 v[68:71], v6 offset:6144
    s_waitcnt lgkmcnt(10)
    v_mfma_f32_16x16x32_bf16 v[112:115], v[16:19], v[72:75], v[112:115]
    ds_read_b128 v[48:51], v4 offset:6144
    v_mfma_f32_16x16x32_bf16 v[144:147], v[20:23], v[72:75], v[144:147]
    buffer_load_dwordx4 v8, s[16:19], s52 offen lds
    s_add_u32 m0, m0, 1024
    v_mfma_f32_16x16x32_bf16 v[176:179], v[24:27], v[72:75], v[176:179]
    s_add_u32 s52, s52, 9216
    v_mfma_f32_16x16x32_bf16 v[208:211], v[28:31], v[72:75], v[208:211]
    ds_read_b128 v[72:75], v5 offset:8192
    s_waitcnt lgkmcnt(11)
    v_mfma_f32_16x16x32_bf16 v[116:119], v[16:19], v[76:79], v[116:119]
    v_mfma_f32_16x16x32_bf16 v[148:151], v[20:23], v[76:79], v[148:151]
    v_mfma_f32_16x16x32_bf16 v[180:183], v[24:27], v[76:79], v[180:183]
    v_mfma_f32_16x16x32_bf16 v[212:215], v[28:31], v[76:79], v[212:215]
    ds_read_b128 v[76:79], v5 offset:10240
    s_waitcnt lgkmcnt(11)
    v_mfma_f32_16x16x32_bf16 v[120:123], v[16:19], v[80:83], v[120:123]
    buffer_load_dwordx4 v9, s[16:19], s52 offen lds
    s_add_u32 m0, m0, 1024
    v_mfma_f32_16x16x32_bf16 v[152:155], v[20:23], v[80:83], v[152:155]
    s_add_u32 s52, s52, 9216
    v_mfma_f32_16x16x32_bf16 v[184:187], v[24:27], v[80:83], v[184:187]
    v_mfma_f32_16x16x32_bf16 v[216:219], v[28:31], v[80:83], v[216:219]
    ds_read_b128 v[80:83], v5 offset:12288
    s_waitcnt lgkmcnt(11)
    v_mfma_f32_16x16x32_bf16 v[124:127], v[16:19], v[84:87], v[124:127]
    v_mfma_f32_16x16x32_bf16 v[156:159], v[20:23], v[84:87], v[156:159]
    v_mfma_f32_16x16x32_bf16 v[188:191], v[24:27], v[84:87], v[188:191]
    v_mfma_f32_16x16x32_bf16 v[220:223], v[28:31], v[84:87], v[220:223]
    ds_read_b128 v[84:87], v5 offset:14336
    s_waitcnt lgkmcnt(4)
    v_mfma_f32_16x16x32_bf16 v[96:99], v[36:39], v[56:59], v[96:99]
    buffer_load_dwordx4 v8, s[16:19], s52 offen lds
    s_add_u32 m0, m0, 1024
    v_mfma_f32_16x16x32_bf16 v[128:131], v[40:43], v[56:59], v[128:131]
    s_add_u32 s57, s57, 40960

    v_mfma_f32_16x16x32_bf16 v[160:163], v[44:47], v[56:59], v[160:163]
    s_cmp_ge_u32 s57, s77
    s_cselect_b32 s57, s76, s57
    v_mfma_f32_16x16x32_bf16 v[192:195], v[48:51], v[56:59], v[192:195]
    v_mfma_f32_16x16x32_bf16 v[100:103], v[36:39], v[60:63], v[100:103]
    v_add_u32 v3, s57, v10
    v_xor_b32 v4, 64, v3
    v_mfma_f32_16x16x32_bf16 v[132:135], v[40:43], v[60:63], v[132:135]
    v_xor_b32 v5, 16384, v5
    v_xor_b32 v6, 16384, v6
    v_mfma_f32_16x16x32_bf16 v[164:167], v[44:47], v[60:63], v[164:167]
    s_add_u32 s56, s56, 1
    s_cmp_eq_u32 s56, 8
    v_mfma_f32_16x16x32_bf16 v[196:199], v[48:51], v[60:63], v[196:199]
    s_cbranch_scc1 L_fin8
    s_waitcnt vmcnt(5) lgkmcnt(0)
    s_barrier
    v_mfma_f32_16x16x32_bf16 v[104:107], v[36:39], v[64:67], v[104:107]
    ds_read_b128 v[56:59], v5 offset:0
    s_add_u32 s52, s52, 9216
    v_mfma_f32_16x16x32_bf16 v[136:139], v[40:43], v[64:67], v[136:139]
    ds_read_b128 v[16:19], v3 offset:0
    buffer_load_dwordx4 v9, s[16:19], s52 offen lds
    v_mfma_f32_16x16x32_bf16 v[168:171], v[44:47], v[64:67], v[168:171]
    ds_read_b128 v[60:63], v5 offset:2048
    s_add_u32 m0, m0, 1024
    v_mfma_f32_16x16x32_bf16 v[200:203], v[48:51], v[64:67], v[200:203]
    ds_read_b128 v[64:67], v5 offset:4096
    v_mfma_f32_16x16x32_bf16 v[108:111], v[36:39], v[68:71], v[108:111]
    ds_read_b128 v[20:23], v3 offset:2048
    s_add_u32 s52, s52, 9216
    v_mfma_f32_16x16x32_bf16 v[140:143], v[40:43], v[68:71], v[140:143]
    ds_read_b128 v[24:27], v3 offset:4096
    v_mfma_f32_16x16x32_bf16 v[172:175], v[44:47], v[68:71], v[172:175]
    ds_read_b128 v[28:31], v3 offset:6144
    buffer_load_dwordx4 v8, s[16:19], s52 offen lds
    v_mfma_f32_16x16x32_bf16 v[204:207], v[48:51], v[68:71], v[204:207]
    ds_read_b128 v[68:71], v5 offset:6144
    v_mfma_f32_16x16x32_bf16 v[112:115], v[36:39], v[72:75], v[112:115]
    s_add_u32 m0, m0, 1024
    s_add_u32 s52, s52, 9216
    v_mfma_f32_16x16x32_bf16 v[144:147], v[40:43], v[72:75], v[144:147]
    v_mfma_f32_16x16x32_bf16 v[176:179], v[44:47], v[72:75], v[176:179]
    v_mfma_f32_16x16x32_bf16 v[208:211], v[48:51], v[72:75], v[208:211]
    ds_read_b128 v[72:75], v6 offset:8192
    v_mfma_f32_16x16x32_bf16 v[116:119], v[36:39], v[76:79], v[116:119]
    v_mfma_f32_16x16x32_bf16 v[148:151], v[40:43], v[76:79], v[148:151]
    v_mfma_f32_16x16x32_bf16 v[180:183], v[44:47], v[76:79], v[180:183]
    buffer_load_dwordx4 v9, s[16:19], s52 offen lds
    s_and_b32 s59, s48, 15
    v_mfma_f32_16x16x32_bf16 v[212:215], v[48:51], v[76:79], v[212:215]
    ds_read_b128 v[76:79], v6 offset:10240
    v_mfma_f32_16x16x32_bf16 v[120:123], v[36:39], v[80:83], v[120:123]
    s_lshr_b32 s48, s48, 4
    s_add_u32 s53, s53, 40960
    v_mfma_f32_16x16x32_bf16 v[152:155], v[40:43], v[80:83], v[152:155]
    s_cmp_ge_u32 s53, s75
    s_cselect_b32 s53, s74, s53
    v_mfma_f32_16x16x32_bf16 v[184:187], v[44:47], v[80:83], v[184:187]
    v_mfma_f32_16x16x32_bf16 v[216:219], v[48:51], v[80:83], v[216:219]
    ds_read_b128 v[80:83], v6 offset:12288
    v_mfma_f32_16x16x32_bf16 v[124:127], v[36:39], v[84:87], v[124:127]
    v_mfma_f32_16x16x32_bf16 v[156:159], v[40:43], v[84:87], v[156:159]
    v_mfma_f32_16x16x32_bf16 v[188:191], v[44:47], v[84:87], v[188:191]
    v_mfma_f32_16x16x32_bf16 v[220:223], v[48:51], v[84:87], v[220:223]
    ds_read_b128 v[84:87], v6 offset:14336
    s_branch L_cmid8
L_fin8:
    v_mfma_f32_16x16x32_bf16 v[104:107], v[36:39], v[64:67], v[104:107]
    v_mfma_f32_16x16x32_bf16 v[136:139], v[40:43], v[64:67], v[136:139]
    v_mfma_f32_16x16x32_bf16 v[168:171], v[44:47], v[64:67], v[168:171]
    v_mfma_f32_16x16x32_bf16 v[200:203], v[48:51], v[64:67], v[200:203]
    v_mfma_f32_16x16x32_bf16 v[108:111], v[36:39], v[68:71], v[108:111]
    v_mfma_f32_16x16x32_bf16 v[140:143], v[40:43], v[68:71], v[140:143]
    v_mfma_f32_16x16x32_bf16 v[172:175], v[44:47], v[68:71], v[172:175]
    v_mfma_f32_16x16x32_bf16 v[204:207], v[48:51], v[68:71], v[204:207]
    s_waitcnt lgkmcnt(3)
    v_mfma_f32_16x16x32_bf16 v[112:115], v[36:39], v[72:75], v[112:115]
    v_mfma_f32_16x16x32_bf16 v[144:147], v[40:43], v[72:75], v[144:147]
    v_mfma_f32_16x16x32_bf16 v[176:179], v[44:47], v[72:75], v[176:179]
    v_mfma_f32_16x16x32_bf16 v[208:211], v[48:51], v[72:75], v[208:211]
    s_waitcnt lgkmcnt(2)
    v_mfma_f32_16x16x32_bf16 v[116:119], v[36:39], v[76:79], v[116:119]
    v_mfma_f32_16x16x32_bf16 v[148:151], v[40:43], v[76:79], v[148:151]
    v_mfma_f32_16x16x32_bf16 v[180:183], v[44:47], v[76:79], v[180:183]
    v_mfma_f32_16x16x32_bf16 v[212:215], v[48:51], v[76:79], v[212:215]
    s_waitcnt lgkmcnt(1)
    v_mfma_f32_16x16x32_bf16 v[120:123], v[36:39], v[80:83], v[120:123]
    v_mfma_f32_16x16x32_bf16 v[152:155], v[40:43], v[80:83], v[152:155]
    v_mfma_f32_16x16x32_bf16 v[184:187], v[44:47], v[80:83], v[184:187]
    v_mfma_f32_16x16x32_bf16 v[216:219], v[48:51], v[80:83], v[216:219]
    s_waitcnt lgkmcnt(0)
    v_mfma_f32_16x16x32_bf16 v[124:127], v[36:39], v[84:87], v[124:127]
    v_mfma_f32_16x16x32_bf16 v[156:159], v[40:43], v[84:87], v[156:159]
    v_mfma_f32_16x16x32_bf16 v[188:191], v[44:47], v[84:87], v[188:191]
    v_mfma_f32_16x16x32_bf16 v[220:223], v[48:51], v[84:87], v[220:223]
    s_waitcnt vmcnt(5)
    s_barrier
    ds_read_b128 v[56:59], v5 offset:0
    ds_read_b128 v[48:51], v3 offset:0
    ds_read_b128 v[60:63], v5 offset:2048
    ds_read_b128 v[64:67], v5 offset:4096
    ds_read_b128 v[68:71], v5 offset:6144
    ds_read_b128 v[72:75], v6 offset:8192
    ds_read_b128 v[76:79], v6 offset:10240
    ds_read_b128 v[80:83], v6 offset:12288
    ds_read_b128 v[84:87], v6 offset:14336
    ds_read_b128 v[52:55], v4 offset:0
    ds_read_b128 v[16:19], v6 offset:0
    ds_read_b128 v[20:23], v6 offset:2048
    ds_read_b128 v[24:27], v6 offset:4096
    ds_read_b128 v[28:31], v6 offset:6144
    s_waitcnt lgkmcnt(12)
    v_mfma_f32_16x16x32_bf16 v[96:99], v[48:51], v[56:59], v[96:99]
    ds_read_b128 v[32:35], v5 offset:8192
    s_waitcnt lgkmcnt(12)
    v_mfma_f32_16x16x32_bf16 v[100:103], v[48:51], v[60:63], v[100:103]
    ds_read_b128 v[36:39], v5 offset:10240
    s_waitcnt lgkmcnt(12)
    v_mfma_f32_16x16x32_bf16 v[104:107], v[48:51], v[64:67], v[104:107]
    ds_read_b128 v[40:43], v5 offset:12288
    s_waitcnt lgkmcnt(12)
    v_mfma_f32_16x16x32_bf16 v[108:111], v[48:51], v[68:71], v[108:111]
    ds_read_b128 v[44:47], v5 offset:14336
    s_waitcnt lgkmcnt(12)
    v_mfma_f32_16x16x32_bf16 v[112:115], v[48:51], v[72:75], v[112:115]
    s_waitcnt lgkmcnt(11)
    v_mfma_f32_16x16x32_bf16 v[116:119], v[48:51], v[76:79], v[116:119]
    s_waitcnt lgkmcnt(10)
    v_mfma_f32_16x16x32_bf16 v[120:123], v[48:51], v[80:83], v[120:123]
    s_waitcnt lgkmcnt(9)
    v_mfma_f32_16x16x32_bf16 v[124:127], v[48:51], v[84:87], v[124:127]
    ds_read_b128 v[48:51], v3 offset:2048
    s_waitcnt lgkmcnt(8)
    v_mfma_f32_16x16x32_bf16 v[96:99], v[52:55], v[16:19], v[96:99]
    s_waitcnt lgkmcnt(7)
    v_mfma_f32_16x16x32_bf16 v[100:103], v[52:55], v[20:23], v[100:103]
    s_waitcnt lgkmcnt(6)
    v_mfma_f32_16x16x32_bf16 v[104:107], v[52:55], v[24:27], v[104:107]
    s_waitcnt lgkmcnt(5)
    v_mfma_f32_16x16x32_bf16 v[108:111], v[52:55], v[28:31], v[108:111]
    s_waitcnt lgkmcnt(4)
    v_mfma_f32_16x16x32_bf16 v[112:115], v[52:55], v[32:35], v[112:115]
    s_waitcnt lgkmcnt(3)
    v_mfma_f32_16x16x32_bf16 v[116:119], v[52:55], v[36:39], v[116:119]
    s_waitcnt lgkmcnt(2)
    v_mfma_f32_16x16x32_bf16 v[120:123], v[52:55], v[40:43], v[120:123]
    s_waitcnt lgkmcnt(1)
    v_mfma_f32_16x16x32_bf16 v[124:127], v[52:55], v[44:47], v[124:127]
    ds_read_b128 v[52:55], v4 offset:2048
    s_waitcnt lgkmcnt(1)
    v_mfma_f32_16x16x32_bf16 v[128:131], v[48:51], v[56:59], v[128:131]
    s_mov_b32 s50, 0
    v_cvt_pk_bf16_f32 v88, v96, v100
    v_mfma_f32_16x16x32_bf16 v[132:135], v[48:51], v[60:63], v[132:135]
    v_cvt_pk_bf16_f32 v89, v104, v108
    v_cvt_pk_bf16_f32 v90, v112, v116
    v_mfma_f32_16x16x32_bf16 v[136:139], v[48:51], v[64:67], v[136:139]
    v_cvt_pk_bf16_f32 v91, v120, v124
    buffer_store_dwordx4 v[88:91], v7, s[36:39], s50 offen sc1 nt
    v_mfma_f32_16x16x32_bf16 v[140:143], v[48:51], v[68:71], v[140:143]
    s_mov_b32 s50, 9216
    v_cvt_pk_bf16_f32 v92, v97, v101
    v_mfma_f32_16x16x32_bf16 v[144:147], v[48:51], v[72:75], v[144:147]
    v_cvt_pk_bf16_f32 v93, v105, v109
    v_cvt_pk_bf16_f32 v94, v113, v117
    v_mfma_f32_16x16x32_bf16 v[148:151], v[48:51], v[76:79], v[148:151]
    v_cvt_pk_bf16_f32 v95, v121, v125
    buffer_store_dwordx4 v[92:95], v7, s[36:39], s50 offen sc1 nt
    v_mfma_f32_16x16x32_bf16 v[152:155], v[48:51], v[80:83], v[152:155]
    s_mov_b32 s50, 18432
    v_cvt_pk_bf16_f32 v8, v98, v102
    v_mfma_f32_16x16x32_bf16 v[156:159], v[48:51], v[84:87], v[156:159]
    ds_read_b128 v[48:51], v3 offset:4096
    s_waitcnt lgkmcnt(1)
    v_mfma_f32_16x16x32_bf16 v[128:131], v[52:55], v[16:19], v[128:131]
    v_cvt_pk_bf16_f32 v9, v106, v110
    v_cvt_pk_bf16_f32 v10, v114, v118
    v_mfma_f32_16x16x32_bf16 v[132:135], v[52:55], v[20:23], v[132:135]
    v_cvt_pk_bf16_f32 v11, v122, v126
    buffer_store_dwordx4 v[8:11], v7, s[36:39], s50 offen sc1 nt
    v_mfma_f32_16x16x32_bf16 v[136:139], v[52:55], v[24:27], v[136:139]
    s_mov_b32 s50, 27648
    v_cvt_pk_bf16_f32 v12, v99, v103
    v_mfma_f32_16x16x32_bf16 v[140:143], v[52:55], v[28:31], v[140:143]
    v_cvt_pk_bf16_f32 v13, v107, v111
    v_cvt_pk_bf16_f32 v14, v115, v119
    v_mfma_f32_16x16x32_bf16 v[144:147], v[52:55], v[32:35], v[144:147]
    v_cvt_pk_bf16_f32 v15, v123, v127
    buffer_store_dwordx4 v[12:15], v7, s[36:39], s50 offen sc1 nt
    v_mfma_f32_16x16x32_bf16 v[148:151], v[52:55], v[36:39], v[148:151]
    v_mfma_f32_16x16x32_bf16 v[152:155], v[52:55], v[40:43], v[152:155]
    v_mfma_f32_16x16x32_bf16 v[156:159], v[52:55], v[44:47], v[156:159]
    ds_read_b128 v[52:55], v4 offset:4096
    s_waitcnt lgkmcnt(1)
    v_mfma_f32_16x16x32_bf16 v[160:163], v[48:51], v[56:59], v[160:163]
    s_mov_b32 s50, 147456
    v_cvt_pk_bf16_f32 v88, v128, v132
    v_mfma_f32_16x16x32_bf16 v[164:167], v[48:51], v[60:63], v[164:167]
    v_cvt_pk_bf16_f32 v89, v136, v140
    v_cvt_pk_bf16_f32 v90, v144, v148
    v_mfma_f32_16x16x32_bf16 v[168:171], v[48:51], v[64:67], v[168:171]
    v_cvt_pk_bf16_f32 v91, v152, v156
    buffer_store_dwordx4 v[88:91], v7, s[36:39], s50 offen sc1 nt
    v_mfma_f32_16x16x32_bf16 v[172:175], v[48:51], v[68:71], v[172:175]
    s_mov_b32 s50, 156672
    v_cvt_pk_bf16_f32 v92, v129, v133
    v_mfma_f32_16x16x32_bf16 v[176:179], v[48:51], v[72:75], v[176:179]
    v_cvt_pk_bf16_f32 v93, v137, v141
    v_cvt_pk_bf16_f32 v94, v145, v149
    v_mfma_f32_16x16x32_bf16 v[180:183], v[48:51], v[76:79], v[180:183]
    v_cvt_pk_bf16_f32 v95, v153, v157
    buffer_store_dwordx4 v[92:95], v7, s[36:39], s50 offen sc1 nt
    v_mfma_f32_16x16x32_bf16 v[184:187], v[48:51], v[80:83], v[184:187]
    s_mov_b32 s50, 165888
    v_cvt_pk_bf16_f32 v8, v130, v134
    v_mfma_f32_16x16x32_bf16 v[188:191], v[48:51], v[84:87], v[188:191]
    ds_read_b128 v[48:51], v3 offset:6144
    s_waitcnt lgkmcnt(1)
    v_mfma_f32_16x16x32_bf16 v[160:163], v[52:55], v[16:19], v[160:163]
    v_cvt_pk_bf16_f32 v9, v138, v142
    v_cvt_pk_bf16_f32 v10, v146, v150
    v_mfma_f32_16x16x32_bf16 v[164:167], v[52:55], v[20:23], v[164:167]
    v_cvt_pk_bf16_f32 v11, v154, v158
    buffer_store_dwordx4 v[8:11], v7, s[36:39], s50 offen sc1 nt
    v_mfma_f32_16x16x32_bf16 v[168:171], v[52:55], v[24:27], v[168:171]
    s_mov_b32 s50, 175104
    v_cvt_pk_bf16_f32 v12, v131, v135
    v_mfma_f32_16x16x32_bf16 v[172:175], v[52:55], v[28:31], v[172:175]
    v_cvt_pk_bf16_f32 v13, v139, v143
    v_cvt_pk_bf16_f32 v14, v147, v151
    v_mfma_f32_16x16x32_bf16 v[176:179], v[52:55], v[32:35], v[176:179]
    v_cvt_pk_bf16_f32 v15, v155, v159
    buffer_store_dwordx4 v[12:15], v7, s[36:39], s50 offen sc1 nt
    v_mfma_f32_16x16x32_bf16 v[180:183], v[52:55], v[36:39], v[180:183]
    v_mfma_f32_16x16x32_bf16 v[184:187], v[52:55], v[40:43], v[184:187]
    v_mfma_f32_16x16x32_bf16 v[188:191], v[52:55], v[44:47], v[188:191]
    ds_read_b128 v[52:55], v4 offset:6144
    s_waitcnt lgkmcnt(1)
    v_mfma_f32_16x16x32_bf16 v[192:195], v[48:51], v[56:59], v[192:195]
    s_mov_b32 s50, 294912
    v_cvt_pk_bf16_f32 v88, v160, v164
    v_mfma_f32_16x16x32_bf16 v[196:199], v[48:51], v[60:63], v[196:199]
    v_cvt_pk_bf16_f32 v89, v168, v172
    v_cvt_pk_bf16_f32 v90, v176, v180
    v_mfma_f32_16x16x32_bf16 v[200:203], v[48:51], v[64:67], v[200:203]
    v_cvt_pk_bf16_f32 v91, v184, v188
    buffer_store_dwordx4 v[88:91], v7, s[36:39], s50 offen sc1 nt
    v_mfma_f32_16x16x32_bf16 v[204:207], v[48:51], v[68:71], v[204:207]
    s_mov_b32 s50, 304128
    v_cvt_pk_bf16_f32 v92, v161, v165
    v_mfma_f32_16x16x32_bf16 v[208:211], v[48:51], v[72:75], v[208:211]
    v_cvt_pk_bf16_f32 v93, v169, v173
    v_cvt_pk_bf16_f32 v94, v177, v181
    v_mfma_f32_16x16x32_bf16 v[212:215], v[48:51], v[76:79], v[212:215]
    v_cvt_pk_bf16_f32 v95, v185, v189
    buffer_store_dwordx4 v[92:95], v7, s[36:39], s50 offen sc1 nt
    v_mfma_f32_16x16x32_bf16 v[216:219], v[48:51], v[80:83], v[216:219]
    s_mov_b32 s50, 313344
    v_cvt_pk_bf16_f32 v8, v162, v166
    v_mfma_f32_16x16x32_bf16 v[220:223], v[48:51], v[84:87], v[220:223]
    v_cvt_pk_bf16_f32 v9, v170, v174
    s_waitcnt lgkmcnt(0)
    v_mfma_f32_16x16x32_bf16 v[192:195], v[52:55], v[16:19], v[192:195]
    v_cvt_pk_bf16_f32 v10, v178, v182
    v_cvt_pk_bf16_f32 v11, v186, v190
    v_mfma_f32_16x16x32_bf16 v[196:199], v[52:55], v[20:23], v[196:199]
    buffer_store_dwordx4 v[8:11], v7, s[36:39], s50 offen sc1 nt
    s_mov_b32 s50, 322560
    v_mfma_f32_16x16x32_bf16 v[200:203], v[52:55], v[24:27], v[200:203]
    v_cvt_pk_bf16_f32 v12, v163, v167
    v_cvt_pk_bf16_f32 v13, v171, v175
    v_mfma_f32_16x16x32_bf16 v[204:207], v[52:55], v[28:31], v[204:207]
    v_cvt_pk_bf16_f32 v14, v179, v183
    v_cvt_pk_bf16_f32 v15, v187, v191
    v_mfma_f32_16x16x32_bf16 v[208:211], v[52:55], v[32:35], v[208:211]
    buffer_store_dwordx4 v[12:15], v7, s[36:39], s50 offen sc1 nt
    v_mfma_f32_16x16x32_bf16 v[212:215], v[52:55], v[36:39], v[212:215]
    v_mfma_f32_16x16x32_bf16 v[216:219], v[52:55], v[40:43], v[216:219]
    v_mfma_f32_16x16x32_bf16 v[220:223], v[52:55], v[44:47], v[220:223]
    s_nop 7
    s_mov_b32 s50, 442368
    v_cvt_pk_bf16_f32 v88, v192, v196
    v_cvt_pk_bf16_f32 v89, v200, v204
    v_cvt_pk_bf16_f32 v90, v208, v212
    v_cvt_pk_bf16_f32 v91, v216, v220
    buffer_store_dwordx4 v[88:91], v7, s[36:39], s50 offen sc1 nt
    s_mov_b32 s50, 451584
    v_cvt_pk_bf16_f32 v92, v193, v197
    v_cvt_pk_bf16_f32 v93, v201, v205
    v_cvt_pk_bf16_f32 v94, v209, v213
    v_cvt_pk_bf16_f32 v95, v217, v221
    buffer_store_dwordx4 v[92:95], v7, s[36:39], s50 offen sc1 nt
    s_mov_b32 s50, 460800
    v_cvt_pk_bf16_f32 v8, v194, v198
    v_cvt_pk_bf16_f32 v9, v202, v206
    v_cvt_pk_bf16_f32 v10, v210, v214
    v_cvt_pk_bf16_f32 v11, v218, v222
    buffer_store_dwordx4 v[8:11], v7, s[36:39], s50 offen sc1 nt
    s_mov_b32 s50, 470016
    v_cvt_pk_bf16_f32 v12, v195, v199
    v_cvt_pk_bf16_f32 v13, v203, v207
    v_cvt_pk_bf16_f32 v14, v211, v215
    v_cvt_pk_bf16_f32 v15, v219, v223
    buffer_store_dwordx4 v[12:15], v7, s[36:39], s50 offen sc1 nt
    s_branch L_end
L_cons10:
    s_barrier
    ds_read_b128 v[56:59], v5 offset:0
    ds_read_b128 v[16:19], v3 offset:0
    ds_read_b128 v[60:63], v5 offset:2048
    ds_read_b128 v[20:23], v3 offset:2048
    ds_read_b128 v[64:67], v5 offset:4096
    ds_read_b128 v[24:27], v3 offset:4096
    ds_read_b128 v[28:31], v3 offset:6144
    ds_read_b128 v[32:35], v3 offset:8192
    ds_read_b128 v[68:71], v5 offset:6144
    ds_read_b128 v[72:75], v6 offset:8192
    ds_read_b128 v[76:79], v6 offset:10240
    ds_read_b128 v[80:83], v6 offset:12288
    ds_read_b128 v[84:87], v6 offset:14336
    s_mov_b32 m0, s53
    s_lshl_b32 s52, s59, 7
    buffer_load_dwordx4 v8, s[16:19], s52 offen lds
    s_add_u32 m0, m0, 1024
    s_add_u32 s52, s52, 9216
    buffer_load_dwordx4 v9, s[16:19], s52 offen lds
    s_add_u32 m0, m0, 1024
    s_add_u32 s52, s52, 9216
    buffer_load_dwordx4 v8, s[16:19], s52 offen lds
    s_add_u32 m0, m0, 1024
    s_add_u32 s52, s52, 9216
    buffer_load_dwordx4 v9, s[16:19], s52 offen lds
    s_add_u32 m0, m0, 1024
    s_add_u32 s52, s52, 9216
    buffer_load_dwordx4 v8, s[16:19], s52 offen lds
    s_and_b32 s59, s48, 15
    s_lshr_b32 s48, s48, 4
    s_add_u32 s53, s53, 40960
    s_cmp_ge_u32 s53, s75
    s_cselect_b32 s53, s74, s53
L_cmid10:
    s_waitcnt lgkmcnt(5)
    v_mfma_f32_16x16x32_bf16 v[96:99], v[16:19], v[56:59], v[96:99]
    s_cmp_eq_u32 s56, 7
    s_cselect_b32 s18, 0, s18
    v_mfma_f32_16x16x32_bf16 v[128:131], v[20:23], v[56:59], v[128:131]
    s_mov_b32 m0, s53
    s_lshl_b32 s52, s59, 7
    v_mfma_f32_16x16x32_bf16 v[160:163], v[24:27], v[56:59], v[160:163]
    buffer_load_dwordx4 v8, s[16:19], s52 offen lds
    s_add_u32 m0, m0, 1024
    v_mfma_f32_16x16x32_bf16 v[192:195], v[28:31], v[56:59], v[192:195]
    s_add_u32 s52, s52, 9216
    v_mfma_f32_16x16x32_bf16 v[224:227], v[32:35], v[56:59], v[224:227]
    ds_read_b128 v[56:59], v6 offset:0
    v_mfma_f32_16x16x32_bf16 v[100:103], v[16:19], v[60:63], v[100:103]
    ds_read_b128 v[36:39], v4 offset:0
    v_mfma_f32_16x16x32_bf16 v[132:135], v[20:23], v[60:63], v[132:135]
    v_mfma_f32_16x16x32_bf16 v[164:167], v[24:27], v[60:63], v[164:167]
    v_mfma_f32_16x16x32_bf16 v[196:199], v[28:31], v[60:63], v[196:199]
    v_mfma_f32_16x16x32_bf16 v[228:231], v[32:35], v[60:63], v[228:231]
    ds_read_b128 v[60:63], v6 offset:2048
    v_mfma_f32_16x16x32_bf16 v[104:107], v[16:19], v[64:67], v[104:107]
    ds_read_b128 v[40:43], v4 offset:2048
    v_mfma_f32_16x16x32_bf16 v[136:139], v[20:23], v[64:67], v[136:139]
    v_mfma_f32_16x16x32_bf16 v[168:171], v[24:27], v[64:67], v[168:171]
    v_mfma_f32_16x16x32_bf16 v[200:203], v[28:31], v[64:67], v[200:203]
    v_mfma_f32_16x16x32_bf16 v[232:235], v[32:35], v[64:67], v[232:235]
    ds_read_b128 v[64:67], v6 offset:4096
    s_waitcnt lgkmcnt(9)
    v_mfma_f32_16x16x32_bf16 v[108:111], v[16:19], v[68:71], v[108:111]
    ds_read_b128 v[44:47], v4 offset:4096
    v_mfma_f32_16x16x32_bf16 v[140:143], v[20:23], v[68:71], v[140:143]
    v_mfma_f32_16x16x32_bf16 v[172:175], v[24:27], v[68:71], v[172:175]
    buffer_load_dwordx4 v9, s[16:19], s52 offen lds
    s_add_u32 m0, m0, 1024
    v_mfma_f32_16x16x32_bf16 v[204:207], v[28:31], v[68:71], v[204:207]
    s_add_u32 s52, s52, 9216
    v_mfma_f32_16x16x32_bf16 v[236:239], v[32:35], v[68:71], v[236:239]
    ds_read_b128 v[68:71], v6 offset:6144
    s_waitcnt lgkmcnt(10)
    v_mfma_f32_16x16x32_bf16 v[112:115], v[16:19], v[72:75], v[112:115]
    ds_read_b128 v[48:51], v4 offset:6144
    v_mfma_f32_16x16x32_bf16 v[144:147], v[20:23], v[72:75], v[144:147]
    v_mfma_f32_16x16x32_bf16 v[176:179], v[24:27], v[72:75], v[176:179]
    v_mfma_f32_16x16x32_bf16 v[208:211], v[28:31], v[72:75], v[208:211]
    v_mfma_f32_16x16x32_bf16 v[240:243], v[32:35], v[72:75], v[240:243]
    ds_read_b128 v[72:75], v5 offset:8192
    s_waitcnt lgkmcnt(11)
    v_mfma_f32_16x16x32_bf16 v[116:119], v[16:19], v[76:79], v[116:119]
    ds_read_b128 v[52:55], v4 offset:8192
    v_mfma_f32_16x16x32_bf16 v[148:151], v[20:23], v[76:79], v[148:151]
    v_mfma_f32_16x16x32_bf16 v[180:183], v[24:27], v[76:79], v[180:183]
    v_mfma_f32_16x16x32_bf16 v[212:215], v[28:31], v[76:79], v[212:215]
    v_mfma_f32_16x16x32_bf16 v[244:247], v[32:35], v[76:79], v[244:247]
    ds_read_b128 v[76:79], v5 offset:10240
    s_waitcnt lgkmcnt(12)
    v_mfma_f32_16x16x32_bf16 v[120:123], v[16:19], v[80:83], v[120:123]
    v_mfma_f32_16x16x32_bf16 v[152:155], v[20:23], v[80:83], v[152:155]
    v_mfma_f32_16x16x32_bf16 v[184:187], v[24:27], v[80:83], v[184:187]
    v_mfma_f32_16x16x32_bf16 v[216:219], v[28:31], v[80:83], v[216:219]
    buffer_load_dwordx4 v8, s[16:19], s52 offen lds
    s_add_u32 m0, m0, 1024
    v_mfma_f32_16x16x32_bf16 v[248:251], v[32:35], v[80:83], v[248:251]
    ds_read_b128 v[80:83], v5 offset:12288
    s_waitcnt lgkmcnt(12)
    v_mfma_f32_16x16x32_bf16 v[124:127], v[16:19], v[84:87], v[124:127]
    s_add_u32 s52, s52, 9216
    v_mfma_f32_16x16x32_bf16 v[156:159], v[20:23], v[84:87], v[156:159]
    v_mfma_f32_16x16x32_bf16 v[188:191], v[24:27], v[84:87], v[188:191]
    v_mfma_f32_16x16x32_bf16 v[220:223], v[28:31], v[84:87], v[220:223]
    v_mfma_f32_16x16x32_bf16 v[252:255], v[32:35], v[84:87], v[252:255]
    ds_read_b128 v[84:87], v5 offset:14336
    s_waitcnt lgkmcnt(3)
    v_mfma_f32_16x16x32_bf16 v[96:99], v[36:39], v[56:59], v[96:99]
    v_mfma_f32_16x16x32_bf16 v[128:131], v[40:43], v[56:59], v[128:131]
    v_mfma_f32_16x16x32_bf16 v[160:163], v[44:47], v[56:59], v[160:163]
    v_mfma_f32_16x16x32_bf16 v[192:195], v[48:51], v[56:59], v[192:195]
    s_add_u32 s57, s57, 40960

    v_mfma_f32_16x16x32_bf16 v[224:227], v[52:55], v[56:59], v[224:227]
    v_mfma_f32_16x16x32_bf16 v[100:103], v[36:39], v[60:63], v[100:103]
    s_cmp_ge_u32 s57, s77
    s_cselect_b32 s57, s76, s57
    v_mfma_f32_16x16x32_bf16 v[132:135], v[40:43], v[60:63], v[132:135]
    v_add_u32 v3, s57, v10
    v_xor_b32 v4, 64, v3
    v_mfma_f32_16x16x32_bf16 v[164:167], v[44:47], v[60:63], v[164:167]
    v_xor_b32 v5, 16384, v5
    v_xor_b32 v6, 16384, v6
    v_mfma_f32_16x16x32_bf16 v[196:199], v[48:51], v[60:63], v[196:199]
    s_add_u32 s56, s56, 1
    s_cmp_eq_u32 s56, 8
    v_mfma_f32_16x16x32_bf16 v[228:231], v[52:55], v[60:63], v[228:231]
    s_cbranch_scc1 L_fin10
    s_waitcnt vmcnt(3) lgkmcnt(0)
    s_barrier
    v_mfma_f32_16x16x32_bf16 v[104:107], v[36:39], v[64:67], v[104:107]
    ds_read_b128 v[56:59], v5 offset:0
    buffer_load_dwordx4 v9, s[16:19], s52 offen lds
    v_mfma_f32_16x16x32_bf16 v[136:139], v[40:43], v[64:67], v[136:139]
    ds_read_b128 v[16:19], v3 offset:0
    s_add_u32 m0, m0, 1024
    v_mfma_f32_16x16x32_bf16 v[168:171], v[44:47], v[64:67], v[168:171]
    ds_read_b128 v[60:63], v5 offset:2048
    s_add_u32 s52, s52, 9216
    v_mfma_f32_16x16x32_bf16 v[200:203], v[48:51], v[64:67], v[200:203]
    ds_read_b128 v[20:23], v3 offset:2048
    v_mfma_f32_16x16x32_bf16 v[232:235], v[52:55], v[64:67], v[232:235]
    ds_read_b128 v[64:67], v5 offset:4096
    v_mfma_f32_16x16x32_bf16 v[108:111], v[36:39], v[68:71], v[108:111]
    ds_read_b128 v[24:27], v3 offset:4096
    v_mfma_f32_16x16x32_bf16 v[140:143], v[40:43], v[68:71], v[140:143]
    ds_read_b128 v[28:31], v3 offset:6144
    v_mfma_f32_16x16x32_bf16 v[172:175], v[44:47], v[68:71], v[172:175]
    ds_read_b128 v[32:35], v3 offset:8192
    v_mfma_f32_16x16x32_bf16 v[204:207], v[48:51], v[68:71], v[204:207]
    v_mfma_f32_16x16x32_bf16 v[236:239], v[52:55], v[68:71], v[236:239]
    ds_read_b128 v[68:71], v5 offset:6144
    v_mfma_f32_16x16x32_bf16 v[112:115], v[36:39], v[72:75], v[112:115]
    v_mfma_f32_16x16x32_bf16 v[144:147], v[40:43], v[72:75], v[144:147]
    v_mfma_f32_16x16x32_bf16 v[176:179], v[44:47], v[72:75], v[176:179]
    v_mfma_f32_16x16x32_bf16 v[208:211], v[48:51], v[72:75], v[208:211]
    v_mfma_f32_16x16x32_bf16 v[240:243], v[52:55], v[72:75], v[240:243]
    ds_read_b128 v[72:75], v6 offset:8192
    v_mfma_f32_16x16x32_bf16 v[116:119], v[36:39], v[76:79], v[116:119]
    v_mfma_f32_16x16x32_bf16 v[148:151], v[40:43], v[76:79], v[148:151]
    buffer_load_dwordx4 v8, s[16:19], s52 offen lds
    s_and_b32 s59, s48, 15
    v_mfma_f32_16x16x32_bf16 v[180:183], v[44:47], v[76:79], v[180:183]
    s_lshr_b32 s48, s48, 4
    s_add_u32 s53, s53, 40960
    v_mfma_f32_16x16x32_bf16 v[212:215], v[48:51], v[76:79], v[212:215]
    s_cmp_ge_u32 s53, s75
    s_cselect_b32 s53, s74, s53
    v_mfma_f32_16x16x32_bf16 v[244:247], v[52:55], v[76:79], v[244:247]
    ds_read_b128 v[76:79], v6 offset:10240
    v_mfma_f32_16x16x32_bf16 v[120:123], v[36:39], v[80:83], v[120:123]
    v_mfma_f32_16x16x32_bf16 v[152:155], v[40:43], v[80:83], v[152:155]
    v_mfma_f32_16x16x32_bf16 v[184:187], v[44:47], v[80:83], v[184:187]
    v_mfma_f32_16x16x32_bf16 v[216:219], v[48:51], v[80:83], v[216:219]
    v_mfma_f32_16x16x32_bf16 v[248:251], v[52:55], v[80:83], v[248:251]
    ds_read_b128 v[80:83], v6 offset:12288
    v_mfma_f32_16x16x32_bf16 v[124:127], v[36:39], v[84:87], v[124:127]
    v_mfma_f32_16x16x32_bf16 v[156:159], v[40:43], v[84:87], v[156:159]
    v_mfma_f32_16x16x32_bf16 v[188:191], v[44:47], v[84:87], v[188:191]
    v_mfma_f32_16x16x32_bf16 v[220:223], v[48:51], v[84:87], v[220:223]
    v_mfma_f32_16x16x32_bf16 v[252:255], v[52:55], v[84:87], v[252:255]
    ds_read_b128 v[84:87], v6 offset:14336
    s_branch L_cmid10
L_fin10:
    v_mfma_f32_16x16x32_bf16 v[104:107], v[36:39], v[64:67], v[104:107]
    v_mfma_f32_16x16x32_bf16 v[136:139], v[40:43], v[64:67], v[136:139]
    v_mfma_f32_16x16x32_bf16 v[168:171], v[44:47], v[64:67], v[168:171]
    v_mfma_f32_16x16x32_bf16 v[200:203], v[48:51], v[64:67], v[200:203]
    v_mfma_f32_16x16x32_bf16 v[232:235], v[52:55], v[64:67], v[232:235]
    v_mfma_f32_16x16x32_bf16 v[108:111], v[36:39], v[68:71], v[108:111]
    v_mfma_f32_16x16x32_bf16 v[140:143], v[40:43], v[68:71], v[140:143]
    v_mfma_f32_16x16x32_bf16 v[172:175], v[44:47], v[68:71], v[172:175]
    v_mfma_f32_16x16x32_bf16 v[204:207], v[48:51], v[68:71], v[204:207]
    v_mfma_f32_16x16x32_bf16 v[236:239], v[52:55], v[68:71], v[236:239]
    v_mfma_f32_16x16x32_bf16 v[112:115], v[36:39], v[72:75], v[112:115]
    v_mfma_f32_16x16x32_bf16 v[144:147], v[40:43], v[72:75], v[144:147]
    v_mfma_f32_16x16x32_bf16 v[176:179], v[44:47], v[72:75], v[176:179]
    v_mfma_f32_16x16x32_bf16 v[208:211], v[48:51], v[72:75], v[208:211]
    v_mfma_f32_16x16x32_bf16 v[240:243], v[52:55], v[72:75], v[240:243]
    s_waitcnt lgkmcnt(2)
    v_mfma_f32_16x16x32_bf16 v[116:119], v[36:39], v[76:79], v[116:119]
    v_mfma_f32_16x16x32_bf16 v[148:151], v[40:43], v[76:79], v[148:151]
    v_mfma_f32_16x16x32_bf16 v[180:183], v[44:47], v[76:79], v[180:183]
    v_mfma_f32_16x16x32_bf16 v[212:215], v[48:51], v[76:79], v[212:215]
    v_mfma_f32_16x16x32_bf16 v[244:247], v[52:55], v[76:79], v[244:247]
    s_waitcnt lgkmcnt(1)
    v_mfma_f32_16x16x32_bf16 v[120:123], v[36:39], v[80:83], v[120:123]
    v_mfma_f32_16x16x32_bf16 v[152:155], v[40:43], v[80:83], v[152:155]
    v_mfma_f32_16x16x32_bf16 v[184:187], v[44:47], v[80:83], v[184:187]
    v_mfma_f32_16x16x32_bf16 v[216:219], v[48:51], v[80:83], v[216:219]
    v_mfma_f32_16x16x32_bf16 v[248:251], v[52:55], v[80:83], v[248:251]
    s_waitcnt lgkmcnt(0)
    v_mfma_f32_16x16x32_bf16 v[124:127], v[36:39], v[84:87], v[124:127]
    v_mfma_f32_16x16x32_bf16 v[156:159], v[40:43], v[84:87], v[156:159]
    v_mfma_f32_16x16x32_bf16 v[188:191], v[44:47], v[84:87], v[188:191]
    v_mfma_f32_16x16x32_bf16 v[220:223], v[48:51], v[84:87], v[220:223]
    v_mfma_f32_16x16x32_bf16 v[252:255], v[52:55], v[84:87], v[252:255]
    s_waitcnt vmcnt(3)
    s_barrier
    ds_read_b128 v[56:59], v5 offset:0
    ds_read_b128 v[48:51], v3 offset:0
    ds_read_b128 v[60:63], v5 offset:2048
    ds_read_b128 v[64:67], v5 offset:4096
    ds_read_b128 v[68:71], v5 offset:6144
    ds_read_b128 v[72:75], v6 offset:8192
    ds_read_b128 v[76:79], v6 offset:10240
    ds_read_b128 v[80:83], v6 offset:12288
    ds_read_b128 v[84:87], v6 offset:14336
    ds_read_b128 v[52:55], v4 offset:0
    ds_read_b128 v[16:19], v6 offset:0
    ds_read_b128 v[20:23], v6 offset:2048
    ds_read_b128 v[24:27], v6 offset:4096
    ds_read_b128 v[28:31], v6 offset:6144
    s_waitcnt lgkmcnt(12)
    v_mfma_f32_16x16x32_bf16 v[96:99], v[48:51], v[56:59], v[96:99]
    ds_read_b128 v[32:35], v5 offset:8192
    s_waitcnt lgkmcnt(12)
    v_mfma_f32_16x16x32_bf16 v[100:103], v[48:51], v[60:63], v[100:103]
    ds_read_b128 v[36:39], v5 offset:10240
    s_waitcnt lgkmcnt(12)
    v_mfma_f32_16x16x32_bf16 v[104:107], v[48:51], v[64:67], v[104:107]
    ds_read_b128 v[40:43], v5 offset:12288
    s_waitcnt lgkmcnt(12)
    v_mfma_f32_16x16x32_bf16 v[108:111], v[48:51], v[68:71], v[108:111]
    ds_read_b128 v[44:47], v5 offset:14336
    s_waitcnt lgkmcnt(12)
    v_mfma_f32_16x16x32_bf16 v[112:115], v[48:51], v[72:75], v[112:115]
    s_waitcnt lgkmcnt(11)
    v_mfma_f32_16x16x32_bf16 v[116:119], v[48:51], v[76:79], v[116:119]
    s_waitcnt lgkmcnt(10)
    v_mfma_f32_16x16x32_bf16 v[120:123], v[48:51], v[80:83], v[120:123]
    s_waitcnt lgkmcnt(9)
    v_mfma_f32_16x16x32_bf16 v[124:127], v[48:51], v[84:87], v[124:127]
    ds_read_b128 v[48:51], v3 offset:2048
    s_waitcnt lgkmcnt(8)
    v_mfma_f32_16x16x32_bf16 v[96:99], v[52:55], v[16:19], v[96:99]
    s_waitcnt lgkmcnt(7)
    v_mfma_f32_16x16x32_bf16 v[100:103], v[52:55], v[20:23], v[100:103]
    s_waitcnt lgkmcnt(6)
    v_mfma_f32_16x16x32_bf16 v[104:107], v[52:55], v[24:27], v[104:107]
    s_waitcnt lgkmcnt(5)
    v_mfma_f32_16x16x32_bf16 v[108:111], v[52:55], v[28:31], v[108:111]
    s_waitcnt lgkmcnt(4)
    v_mfma_f32_16x16x32_bf16 v[112:115], v[52:55], v[32:35], v[112:115]
    s_waitcnt lgkmcnt(3)
    v_mfma_f32_16x16x32_bf16 v[116:119], v[52:55], v[36:39], v[116:119]
    s_waitcnt lgkmcnt(2)
    v_mfma_f32_16x16x32_bf16 v[120:123], v[52:55], v[40:43], v[120:123]
    s_waitcnt lgkmcnt(1)
    v_mfma_f32_16x16x32_bf16 v[124:127], v[52:55], v[44:47], v[124:127]
    ds_read_b128 v[52:55], v4 offset:2048
    s_waitcnt lgkmcnt(1)
    v_mfma_f32_16x16x32_bf16 v[128:131], v[48:51], v[56:59], v[128:131]
    s_mov_b32 s50, 0
    v_cvt_pk_bf16_f32 v88, v96, v100
    v_mfma_f32_16x16x32_bf16 v[132:135], v[48:51], v[60:63], v[132:135]
    v_cvt_pk_bf16_f32 v89, v104, v108
    v_cvt_pk_bf16_f32 v90, v112, v116
    v_mfma_f32_16x16x32_bf16 v[136:139], v[48:51], v[64:67], v[136:139]
    v_cvt_pk_bf16_f32 v91, v120, v124
    buffer_store_dwordx4 v[88:91], v7, s[36:39], s50 offen sc1 nt
    v_mfma_f32_16x16x32_bf16 v[140:143], v[48:51], v[68:71], v[140:143]
    s_mov_b32 s50, 9216
    v_cvt_pk_bf16_f32 v92, v97, v101
    v_mfma_f32_16x16x32_bf16 v[144:147], v[48:51], v[72:75], v[144:147]
    v_cvt_pk_bf16_f32 v93, v105, v109
    v_cvt_pk_bf16_f32 v94, v113, v117
    v_mfma_f32_16x16x32_bf16 v[148:151], v[48:51], v[76:79], v[148:151]
    v_cvt_pk_bf16_f32 v95, v121, v125
    buffer_store_dwordx4 v[92:95], v7, s[36:39], s50 offen sc1 nt
    v_mfma_f32_16x16x32_bf16 v[152:155], v[48:51], v[80:83], v[152:155]
    s_mov_b32 s50, 18432
    v_cvt_pk_bf16_f32 v8, v98, v102
    v_mfma_f32_16x16x32_bf16 v[156:159], v[48:51], v[84:87], v[156:159]
    ds_read_b128 v[48:51], v3 offset:4096
    s_waitcnt lgkmcnt(1)
    v_mfma_f32_16x16x32_bf16 v[128:131], v[52:55], v[16:19], v[128:131]
    v_cvt_pk_bf16_f32 v9, v106, v110
    v_cvt_pk_bf16_f32 v10, v114, v118
    v_mfma_f32_16x16x32_bf16 v[132:135], v[52:55], v[20:23], v[132:135]
    v_cvt_pk_bf16_f32 v11, v122, v126
    buffer_store_dwordx4 v[8:11], v7, s[36:39], s50 offen sc1 nt
    v_mfma_f32_16x16x32_bf16 v[136:139], v[52:55], v[24:27], v[136:139]
    s_mov_b32 s50, 27648
    v_cvt_pk_bf16_f32 v12, v99, v103
    v_mfma_f32_16x16x32_bf16 v[140:143], v[52:55], v[28:31], v[140:143]
    v_cvt_pk_bf16_f32 v13, v107, v111
    v_cvt_pk_bf16_f32 v14, v115, v119
    v_mfma_f32_16x16x32_bf16 v[144:147], v[52:55], v[32:35], v[144:147]
    v_cvt_pk_bf16_f32 v15, v123, v127
    buffer_store_dwordx4 v[12:15], v7, s[36:39], s50 offen sc1 nt
    v_mfma_f32_16x16x32_bf16 v[148:151], v[52:55], v[36:39], v[148:151]
    v_mfma_f32_16x16x32_bf16 v[152:155], v[52:55], v[40:43], v[152:155]
    v_mfma_f32_16x16x32_bf16 v[156:159], v[52:55], v[44:47], v[156:159]
    ds_read_b128 v[52:55], v4 offset:4096
    s_waitcnt lgkmcnt(1)
    v_mfma_f32_16x16x32_bf16 v[160:163], v[48:51], v[56:59], v[160:163]
    s_mov_b32 s50, 147456
    v_cvt_pk_bf16_f32 v88, v128, v132
    v_mfma_f32_16x16x32_bf16 v[164:167], v[48:51], v[60:63], v[164:167]
    v_cvt_pk_bf16_f32 v89, v136, v140
    v_cvt_pk_bf16_f32 v90, v144, v148
    v_mfma_f32_16x16x32_bf16 v[168:171], v[48:51], v[64:67], v[168:171]
    v_cvt_pk_bf16_f32 v91, v152, v156
    buffer_store_dwordx4 v[88:91], v7, s[36:39], s50 offen sc1 nt
    v_mfma_f32_16x16x32_bf16 v[172:175], v[48:51], v[68:71], v[172:175]
    s_mov_b32 s50, 156672
    v_cvt_pk_bf16_f32 v92, v129, v133
    v_mfma_f32_16x16x32_bf16 v[176:179], v[48:51], v[72:75], v[176:179]
    v_cvt_pk_bf16_f32 v93, v137, v141
    v_cvt_pk_bf16_f32 v94, v145, v149
    v_mfma_f32_16x16x32_bf16 v[180:183], v[48:51], v[76:79], v[180:183]
    v_cvt_pk_bf16_f32 v95, v153, v157
    buffer_store_dwordx4 v[92:95], v7, s[36:39], s50 offen sc1 nt
    v_mfma_f32_16x16x32_bf16 v[184:187], v[48:51], v[80:83], v[184:187]
    s_mov_b32 s50, 165888
    v_cvt_pk_bf16_f32 v8, v130, v134
    v_mfma_f32_16x16x32_bf16 v[188:191], v[48:51], v[84:87], v[188:191]
    ds_read_b128 v[48:51], v3 offset:6144
    s_waitcnt lgkmcnt(1)
    v_mfma_f32_16x16x32_bf16 v[160:163], v[52:55], v[16:19], v[160:163]
    v_cvt_pk_bf16_f32 v9, v138, v142
    v_cvt_pk_bf16_f32 v10, v146, v150
    v_mfma_f32_16x16x32_bf16 v[164:167], v[52:55], v[20:23], v[164:167]
    v_cvt_pk_bf16_f32 v11, v154, v158
    buffer_store_dwordx4 v[8:11], v7, s[36:39], s50 offen sc1 nt
    v_mfma_f32_16x16x32_bf16 v[168:171], v[52:55], v[24:27], v[168:171]
    s_mov_b32 s50, 175104
    v_cvt_pk_bf16_f32 v12, v131, v135
    v_mfma_f32_16x16x32_bf16 v[172:175], v[52:55], v[28:31], v[172:175]
    v_cvt_pk_bf16_f32 v13, v139, v143
    v_cvt_pk_bf16_f32 v14, v147, v151
    v_mfma_f32_16x16x32_bf16 v[176:179], v[52:55], v[32:35], v[176:179]
    v_cvt_pk_bf16_f32 v15, v155, v159
    buffer_store_dwordx4 v[12:15], v7, s[36:39], s50 offen sc1 nt
    v_mfma_f32_16x16x32_bf16 v[180:183], v[52:55], v[36:39], v[180:183]
    v_mfma_f32_16x16x32_bf16 v[184:187], v[52:55], v[40:43], v[184:187]
    v_mfma_f32_16x16x32_bf16 v[188:191], v[52:55], v[44:47], v[188:191]
    ds_read_b128 v[52:55], v4 offset:6144
    s_waitcnt lgkmcnt(1)
    v_mfma_f32_16x16x32_bf16 v[192:195], v[48:51], v[56:59], v[192:195]
    s_mov_b32 s50, 294912
    v_cvt_pk_bf16_f32 v88, v160, v164
    v_mfma_f32_16x16x32_bf16 v[196:199], v[48:51], v[60:63], v[196:199]
    v_cvt_pk_bf16_f32 v89, v168, v172
    v_cvt_pk_bf16_f32 v90, v176, v180
    v_mfma_f32_16x16x32_bf16 v[200:203], v[48:51], v[64:67], v[200:203]
    v_cvt_pk_bf16_f32 v91, v184, v188
    buffer_store_dwordx4 v[88:91], v7, s[36:39], s50 offen sc1 nt
    v_mfma_f32_16x16x32_bf16 v[204:207], v[48:51], v[68:71], v[204:207]
    s_mov_b32 s50, 304128
    v_cvt_pk_bf16_f32 v92, v161, v165
    v_mfma_f32_16x16x32_bf16 v[208:211], v[48:51], v[72:75], v[208:211]
    v_cvt_pk_bf16_f32 v93, v169, v173
    v_cvt_pk_bf16_f32 v94, v177, v181
    v_mfma_f32_16x16x32_bf16 v[212:215], v[48:51], v[76:79], v[212:215]
    v_cvt_pk_bf16_f32 v95, v185, v189
    buffer_store_dwordx4 v[92:95], v7, s[36:39], s50 offen sc1 nt
    v_mfma_f32_16x16x32_bf16 v[216:219], v[48:51], v[80:83], v[216:219]
    s_mov_b32 s50, 313344
    v_cvt_pk_bf16_f32 v8, v162, v166
    v_mfma_f32_16x16x32_bf16 v[220:223], v[48:51], v[84:87], v[220:223]
    ds_read_b128 v[48:51], v3 offset:8192
    s_waitcnt lgkmcnt(1)
    v_mfma_f32_16x16x32_bf16 v[192:195], v[52:55], v[16:19], v[192:195]
    v_cvt_pk_bf16_f32 v9, v170, v174
    v_cvt_pk_bf16_f32 v10, v178, v182
    v_mfma_f32_16x16x32_bf16 v[196:199], v[52:55], v[20:23], v[196:199]
    v_cvt_pk_bf16_f32 v11, v186, v190
    buffer_store_dwordx4 v[8:11], v7, s[36:39], s50 offen sc1 nt
    v_mfma_f32_16x16x32_bf16 v[200:203], v[52:55], v[24:27], v[200:203]
    s_mov_b32 s50, 322560
    v_cvt_pk_bf16_f32 v12, v163, v167
    v_mfma_f32_16x16x32_bf16 v[204:207], v[52:55], v[28:31], v[204:207]
    v_cvt_pk_bf16_f32 v13, v171, v175
    v_cvt_pk_bf16_f32 v14, v179, v183
    v_mfma_f32_16x16x32_bf16 v[208:211], v[52:55], v[32:35], v[208:211]
    v_cvt_pk_bf16_f32 v15, v187, v191
    buffer_store_dwordx4 v[12:15], v7, s[36:39], s50 offen sc1 nt
    v_mfma_f32_16x16x32_bf16 v[212:215], v[52:55], v[36:39], v[212:215]
    v_mfma_f32_16x16x32_bf16 v[216:219], v[52:55], v[40:43], v[216:219]
    v_mfma_f32_16x16x32_bf16 v[220:223], v[52:55], v[44:47], v[220:223]
    ds_read_b128 v[52:55], v4 offset:8192
    s_waitcnt lgkmcnt(1)
    v_mfma_f32_16x16x32_bf16 v[224:227], v[48:51], v[56:59], v[224:227]
    s_mov_b32 s50, 442368
    v_cvt_pk_bf16_f32 v88, v192, v196
    v_mfma_f32_16x16x32_bf16 v[228:231], v[48:51], v[60:63], v[228:231]
    v_cvt_pk_bf16_f32 v89, v200, v204
    v_cvt_pk_bf16_f32 v90, v208, v212
    v_mfma_f32_16x16x32_bf16 v[232:235], v[48:51], v[64:67], v[232:235]
    v_cvt_pk_bf16_f32 v91, v216, v220
    buffer_store_dwordx4 v[88:91], v7, s[36:39], s50 offen sc1 nt
    v_mfma_f32_16x16x32_bf16 v[236:239], v[48:51], v[68:71], v[236:239]
    s_mov_b32 s50, 451584
    v_cvt_pk_bf16_f32 v92, v193, v197
    v_mfma_f32_16x16x32_bf16 v[240:243], v[48:51], v[72:75], v[240:243]
    v_cvt_pk_bf16_f32 v93, v201, v205
    v_cvt_pk_bf16_f32 v94, v209, v213
    v_mfma_f32_16x16x32_bf16 v[244:247], v[48:51], v[76:79], v[244:247]
    v_cvt_pk_bf16_f32 v95, v217, v221
    buffer_store_dwordx4 v[92:95], v7, s[36:39], s50 offen sc1 nt
    v_mfma_f32_16x16x32_bf16 v[248:251], v[48:51], v[80:83], v[248:251]
    s_mov_b32 s50, 460800
    v_cvt_pk_bf16_f32 v8, v194, v198
    v_mfma_f32_16x16x32_bf16 v[252:255], v[48:51], v[84:87], v[252:255]
    v_cvt_pk_bf16_f32 v9, v202, v206
    s_waitcnt lgkmcnt(0)
    v_mfma_f32_16x16x32_bf16 v[224:227], v[52:55], v[16:19], v[224:227]
    v_cvt_pk_bf16_f32 v10, v210, v214
    v_cvt_pk_bf16_f32 v11, v218, v222
    v_mfma_f32_16x16x32_bf16 v[228:231], v[52:55], v[20:23], v[228:231]
    buffer_store_dwordx4 v[8:11], v7, s[36:39], s50 offen sc1 nt
    s_mov_b32 s50, 470016
    v_mfma_f32_16x16x32_bf16 v[232:235], v[52:55], v[24:27], v[232:235]
    v_cvt_pk_bf16_f32 v12, v195, v199
    v_cvt_pk_bf16_f32 v13, v203, v207
    v_mfma_f32_16x16x32_bf16 v[236:239], v[52:55], v[28:31], v[236:239]
    v_cvt_pk_bf16_f32 v14, v211, v215
    v_cvt_pk_bf16_f32 v15, v219, v223
    v_mfma_f32_16x16x32_bf16 v[240:243], v[52:55], v[32:35], v[240:243]
    buffer_store_dwordx4 v[12:15], v7, s[36:39], s50 offen sc1 nt
    v_mfma_f32_16x16x32_bf16 v[244:247], v[52:55], v[36:39], v[244:247]
    v_mfma_f32_16x16x32_bf16 v[248:251], v[52:55], v[40:43], v[248:251]
    v_mfma_f32_16x16x32_bf16 v[252:255], v[52:55], v[44:47], v[252:255]
    s_nop 7
    s_mov_b32 s50, 589824
    v_cvt_pk_bf16_f32 v88, v224, v228
    v_cvt_pk_bf16_f32 v89, v232, v236
    v_cvt_pk_bf16_f32 v90, v240, v244
    v_cvt_pk_bf16_f32 v91, v248, v252
    buffer_store_dwordx4 v[88:91], v7, s[36:39], s50 offen sc1 nt
    s_mov_b32 s50, 599040
    v_cvt_pk_bf16_f32 v92, v225, v229
    v_cvt_pk_bf16_f32 v93, v233, v237
    v_cvt_pk_bf16_f32 v94, v241, v245
    v_cvt_pk_bf16_f32 v95, v249, v253
    buffer_store_dwordx4 v[92:95], v7, s[36:39], s50 offen sc1 nt
    s_mov_b32 s50, 608256
    v_cvt_pk_bf16_f32 v8, v226, v230
    v_cvt_pk_bf16_f32 v9, v234, v238
    v_cvt_pk_bf16_f32 v10, v242, v246
    v_cvt_pk_bf16_f32 v11, v250, v254
    buffer_store_dwordx4 v[8:11], v7, s[36:39], s50 offen sc1 nt
    s_mov_b32 s50, 617472
    v_cvt_pk_bf16_f32 v12, v227, v231
    v_cvt_pk_bf16_f32 v13, v235, v239
    v_cvt_pk_bf16_f32 v14, v243, v247
    v_cvt_pk_bf16_f32 v15, v251, v255
    buffer_store_dwordx4 v[12:15], v7, s[36:39], s50 offen sc1 nt
L_end:
L_done:
    s_endpgm
.section .rodata,"a"
.p2align 6
.amdhsa_kernel standalone__weight_only_int_omniquant__prompt_kernel
  .amdhsa_next_free_vgpr 256
  .amdhsa_next_free_sgpr 96
  .amdhsa_accum_offset 256
  .amdhsa_group_segment_fixed_size 0
  .amdhsa_kernarg_size 64
  .amdhsa_user_sgpr_count 2
  .amdhsa_user_sgpr_kernarg_segment_ptr 1
  .amdhsa_system_sgpr_workgroup_id_x 1
.end_amdhsa_kernel
```
